```python
import torch

def _softmax(x, axis=-1):
    return torch.softmax(x, dim=axis)
def _gelu(x):
    return torch.nn.functional.gelu(x, approximate="tanh")
def _silu(x):
    return torch.nn.functional.silu(x)
def _sigmoid(x):
    return torch.sigmoid(x)
def _layernorm(x, axis=-1, eps=1e-5):
    m = x.mean(dim=axis, keepdim=True)
    v = x.var(dim=axis, keepdim=True, unbiased=False)
    return (x - m) / torch.sqrt(v + eps)
def _scatter_add(tgt, idx, src, axis=0):
    return tgt.clone().index_add_(axis, idx, src)
def _segment_sum(src, seg, n):
    out = torch.zeros((n,) + src.shape[1:], dtype=src.dtype)
    return out.index_add_(0, seg, src)
def _pad(x, pw):
    flat = tuple(v for pair in reversed(pw) for v in pair)
    return torch.nn.functional.pad(x, flat)

kernel_name = 'sequential_preLN__sliding_block_cached__geglu_ffn__decode'

def setup_inputs():

    _w = (lambda a: (lambda t: t.to(torch.bfloat16) if t.is_floating_point() else t)(torch.as_tensor(a)))
    def _A_setup():
        B, Sq, D = 2, 1, 512
        Hq, Hkv, Sk, Dh = 32, 32, 4096, 128
        assert Hq % Hkv == 0, (Hq, Hkv)
        return {
            "x": _w((lambda *s: torch.randn(*s, dtype=torch.bfloat16) * 0.05)(B, Sq, D)),
            "k_cache": _w((lambda *s: torch.randn(*s, dtype=torch.bfloat16) * 3.2)(B, Hkv, Sk, Dh)),
            "v_cache": _w((lambda *s: torch.randn(*s, dtype=torch.bfloat16) * 0.4)(B, Hkv, Sk, Dh)),
            "wq": _w((lambda *s: torch.randn(*s, dtype=torch.bfloat16) * 3.2)(D, Hq * Dh) * (D ** -0.5)),
            "wo": _w((lambda *s: torch.randn(*s, dtype=torch.bfloat16) * 0.4)(Hq * Dh, D) * ((Hq * Dh) ** -0.5)),
        }
    _A_in = _A_setup()

    def _B_setup():
        B, S, D, F = 2, 1, 512, 1376
        return {
            "x": _w((lambda *s: torch.randn(*s, dtype=torch.bfloat16) * 0.05)(B, S, D)),
            "w_gate": _w((lambda *s: torch.randn(*s, dtype=torch.bfloat16) * 0.05)(D, F)),
            "w_up": _w((lambda *s: torch.randn(*s, dtype=torch.bfloat16) * 0.05)(D, F)),
            "w_down": _w((lambda *s: torch.randn(*s, dtype=torch.bfloat16) * 0.05)(F, D)),
        }
    _B_in = _B_setup()

    return {
        "A_x": _A_in["x"],
        "A_k_cache": _A_in["k_cache"],
        "A_v_cache": _A_in["v_cache"],
        "A_wq": _A_in["wq"],
        "A_wo": _A_in["wo"],
        "B_x": _B_in["x"],
        "B_w_gate": _B_in["w_gate"],
        "B_w_up": _B_in["w_up"],
        "B_w_down": _B_in["w_down"],
    }

def reference(A_x, A_k_cache, A_v_cache, A_wq, A_wo, B_x, B_w_gate, B_w_up, B_w_down):
    def _A_ref(x, k_cache, v_cache, wq, wo):
        B, Sq, D = x.shape
        Hq, Dh = 32, 128
        Hkv, Sk = k_cache.shape[1], k_cache.shape[2]
        W = min(4096, max(256, Sk // 4))
        rep = Hq // Hkv
        q = (lambda x, *d: x.permute(*d))((x @ wq).reshape(B, Sq, Hq, Dh), 0, 2, 1, 3)
        k = (lambda x, n, axis: torch.repeat_interleave(x, n, dim=axis))(k_cache[:, :, Sk - W:, :], rep, axis=1)
        v = (lambda x, n, axis: torch.repeat_interleave(x, n, dim=axis))(v_cache[:, :, Sk - W:, :], rep, axis=1)
        scores = torch.einsum("bhqd,bhkd->bhqk", q, k) * (Dh ** -0.5)
        p = _softmax(scores, axis=-1)
        o = torch.einsum("bhqk,bhkd->bhqd", p, v)
        return (lambda x, *d: x.permute(*d))(o, 0, 2, 1, 3).reshape(B, Sq, Hq * Dh) @ wo

    def _B_ref(x, w_gate, w_up, w_down):
        return (_gelu(x @ w_gate) * (x @ w_up)) @ w_down

    x = A_x
    h = x + _A_ref(_layernorm(x, axis=-1), A_k_cache, A_v_cache, A_wq, A_wo)
    h2 = h + _B_ref(_layernorm(h, axis=-1), B_w_gate, B_w_up, B_w_down)
    return h2
```

```asm
; @launch grid=(256,1,1) block=(640,1,1) lds=116736
.amdgcn_target "amdgcn-amd-amdhsa--gfx950"
.text
.p2align 12
.globl sequential_preLN__sliding_block_cached__geglu_ffn__decode_kernel
.p2align 8
.type sequential_preLN__sliding_block_cached__geglu_ffn__decode_kernel,@function
sequential_preLN__sliding_block_cached__geglu_ffn__decode_kernel:
    s_load_dwordx16 s[4:19], s[0:1], 0
    s_load_dwordx8 s[20:27], s[0:1], 64
    s_cmp_ge_u32 s2, 256
    s_cbranch_scc1 L_bail
    v_readfirstlane_b32 s31, v0
    v_and_b32 v1, 63, v0
    s_and_b32 s28, s2, 7
    s_lshr_b32 s30, s2, 3
    s_lshr_b32 s29, s2, 6
    s_lshl_b32 s40, s28, 2
    s_add_u32 s29, s29, s40
    s_and_b32 s30, s30, 7
    s_lshr_b32 s31, s31, 6
    s_mov_b32 s38, 0xffff0000
    s_bitcmp0_b32 s30, 1
    s_cselect_b32 s55, 8, 8
    s_cmp_lg_u32 s31, 0
    s_cbranch_scc1 L_stream
L_comm:
    s_setprio 3
    v_lshrrev_b32 v2, 4, v1
    v_bfe_u32 v3, v1, 3, 1
    v_and_b32 v5, 7, v1
    v_lshl_add_u32 v4, v2, 3, v5
    v_lshlrev_b32 v4, 5, v4
    v_lshl_add_u32 v4, v3, 10, v4
    s_lshl_b32 s40, s30, 7
    v_lshl_add_u32 v5, v5, 2, s40
    v_lshl_add_u32 v5, v2, 5, v5
    v_lshl_add_u32 v5, v3, 10, v5
    s_lshl_b32 s40, s30, 19
    s_lshl_b32 s41, s29, 8
    s_add_u32 s40, s40, s41
    s_movk_i32 s41, 0x2000
    v_and_b32 v6, 15, v1
    v_lshl_add_u32 v6, v6, 4, s40
    v_lshl_add_u32 v6, v2, 17, v6
    s_waitcnt lgkmcnt(0)
    global_load_dwordx4 v[8:11], v4, s[4:5]
    global_load_dwordx4 v[12:15], v4, s[4:5] offset:16
    global_load_dword v16, v5, s[4:5]
    global_load_dwordx4 v[24:27], v6, s[10:11] nt
    v_add_u32 v6, s41, v6
    global_load_dwordx4 v[28:31], v6, s[10:11] nt
    v_add_u32 v6, s41, v6
    global_load_dwordx4 v[32:35], v6, s[10:11] nt
    v_add_u32 v6, s41, v6
    global_load_dwordx4 v[36:39], v6, s[10:11] nt
    v_add_u32 v6, s41, v6
    global_load_dwordx4 v[40:43], v6, s[10:11] nt
    v_add_u32 v6, s41, v6
    global_load_dwordx4 v[44:47], v6, s[10:11] nt
    v_add_u32 v6, s41, v6
    global_load_dwordx4 v[48:51], v6, s[10:11] nt
    v_add_u32 v6, s41, v6
    global_load_dwordx4 v[52:55], v6, s[10:11] nt
    v_add_u32 v6, s41, v6
    global_load_dwordx4 v[56:59], v6, s[10:11] nt
    v_add_u32 v6, s41, v6
    global_load_dwordx4 v[60:63], v6, s[10:11] nt
    v_add_u32 v6, s41, v6
    global_load_dwordx4 v[64:67], v6, s[10:11] nt
    v_add_u32 v6, s41, v6
    global_load_dwordx4 v[68:71], v6, s[10:11] nt
    v_add_u32 v6, s41, v6
    global_load_dwordx4 v[72:75], v6, s[10:11] nt
    v_add_u32 v6, s41, v6
    global_load_dwordx4 v[76:79], v6, s[10:11] nt
    v_add_u32 v6, s41, v6
    global_load_dwordx4 v[80:83], v6, s[10:11] nt
    v_add_u32 v6, s41, v6
    global_load_dwordx4 v[84:87], v6, s[10:11] nt
    s_barrier
    s_branch L_comm2
L_stream:
    s_cmp_gt_u32 s31, s55
    s_cbranch_scc1 L_idle
    s_lshr_b32 s40, s30, 2
    s_lshl_b32 s40, s40, 25
    s_lshl_b32 s41, s29, 20
    s_add_u32 s40, s40, s41
    s_and_b32 s41, s30, 1
    s_mul_i32 s41, s41, s55
    s_add_u32 s41, s41, s31
    s_bitcmp1_b32 s30, 1
    s_cselect_b32 s42, 16, 0
    s_add_u32 s41, s41, s42
    s_lshl_b32 s41, s41, 13
    s_add_u32 s40, s40, s41
    s_add_u32 s40, s40, 782336
    v_lshl_add_u32 v2, v1, 4, s40
    s_waitcnt lgkmcnt(0)
    s_barrier
    global_load_dwordx4 v[4:7], v2, s[6:7] offset:-4096 nt
    global_load_dwordx4 v[8:11], v2, s[6:7] offset:-3072 nt
    global_load_dwordx4 v[12:15], v2, s[6:7] offset:-2048 nt
    global_load_dwordx4 v[16:19], v2, s[6:7] offset:-1024 nt
    s_branch L_setup
L_setupr:
    s_barrier
    global_load_dwordx4 v[20:23], v2, s[6:7] offset:0 nt
    global_load_dwordx4 v[24:27], v2, s[6:7] offset:1024 nt
    global_load_dwordx4 v[28:31], v2, s[6:7] offset:2048 nt
    global_load_dwordx4 v[32:35], v2, s[6:7] offset:3072 nt
    global_load_dwordx4 v[36:39], v2, s[8:9] offset:-4096 nt
    s_barrier
    s_barrier
    global_load_dwordx4 v[40:43], v2, s[8:9] offset:-3072 nt
    global_load_dwordx4 v[44:47], v2, s[8:9] offset:-2048 nt
    global_load_dwordx4 v[48:51], v2, s[8:9] offset:-1024 nt
    global_load_dwordx4 v[52:55], v2, s[8:9] offset:0 nt
    global_load_dwordx4 v[56:59], v2, s[8:9] offset:1024 nt
    global_load_dwordx4 v[60:63], v2, s[8:9] offset:2048 nt
    global_load_dwordx4 v[64:67], v2, s[8:9] offset:3072 nt
    s_branch L_stream2
L_idle:
    s_cmp_lg_u32 s31, 9
    s_cbranch_scc1 L_nopf
    s_getpc_b64 s[52:53]
L_pc:
    s_sub_u32 s52, s52, L_pc-sequential_preLN__sliding_block_cached__geglu_ffn__decode_kernel
    s_subb_u32 s53, s53, 0
    s_lshr_b32 s40, s2, 3
    s_min_u32 s40, s40, (L_codeend-sequential_preLN__sliding_block_cached__geglu_ffn__decode_kernel)/1024
    s_lshl_b32 s40, s40, 10
    v_lshl_add_u32 v3, v1, 4, s40
    global_load_dwordx4 v[124:127], v3, s[52:53]
L_nopf:
    s_barrier
    s_waitcnt lgkmcnt(0)
    s_load_dword s32, s[26:27], 0
    s_getreg_b32 s42, hwreg(HW_REG_XCC_ID, 0, 4)
    s_lshl_b32 s40, s28, 7
    s_lshr_b32 s41, s2, 3
    s_lshl_b32 s41, s41, 2
    s_add_u32 s40, s40, s41
    s_add_u32 s40, s40, 1024
    v_mov_b32 v2, s40
    s_waitcnt lgkmcnt(0)
    s_cmp_lg_u32 s31, 9
    s_cbranch_scc1 L_noxt
    s_add_u32 s40, s32, 2654435769
    s_and_b32 s40, s40, 0xffffff00
    s_or_b32 s40, s40, s42
    v_mov_b32 v3, s40
    s_mov_b64 exec, 1
    global_store_dword v2, v3, s[26:27] sc1
    s_mov_b64 exec, -1
L_noxt:
    s_barrier
    s_barrier
    s_barrier
    s_branch L_idle1
L_comm2:
    s_load_dword s32, s[26:27], 0
    v_mov_b32 v6, 352
    v_mov_b32 v104, 0
    v_mov_b32 v105, 0
    v_mov_b32 v106, 0
    v_mov_b32 v107, 0
    ds_write_b128 v6, v[104:107]
    ds_write_b128 v6, v[104:107] offset:16
    ds_write_b64 v6, v[104:105] offset:32
    v_lshlrev_b32 v6, 4, v1
    v_mov_b32 v108, 0x3f803f80
    v_mov_b32 v109, 0x3f803f80
    v_mov_b32 v110, 0x3f803f80
    v_mov_b32 v111, 0x3f803f80
    ds_write_b128 v6, v[108:111] offset:11392
    v_min_u32 v6, 23, v1
    v_cmp_gt_u32 vcc, 12, v6
    v_lshlrev_b32 v6, 2, v6
    v_mov_b32 v105, 0xff800000
    v_cndmask_b32 v105, v104, v105, vcc
    ds_write_b32 v6, v105 offset:256
    v_and_b32 v108, 1, v1
    v_cmp_eq_u32 vcc, 1, v108
    v_mov_b32 v109, 0x0c0c0100
    v_mov_b32 v110, 0x01000c0c
    v_cndmask_b32 v109, v109, v110, vcc
    v_mov_b32 v110, 0x0c0c0302
    v_mov_b32 v111, 0x03020c0c
    v_cndmask_b32 v110, v110, v111, vcc
    v_bfe_u32 v108, v1, 1, 2
    v_mov_b32 v111, 0x0c0c0c0c
    v_cmp_eq_u32 vcc, 0, v108
    s_nop 1
    v_cndmask_b32 v112, v111, v109, vcc
    v_cndmask_b32 v113, v111, v110, vcc
    v_cmp_eq_u32 vcc, 1, v108
    s_nop 1
    v_cndmask_b32 v114, v111, v109, vcc
    v_cndmask_b32 v115, v111, v110, vcc
    v_cmp_eq_u32 vcc, 2, v108
    s_nop 1
    v_cndmask_b32 v116, v111, v109, vcc
    v_cndmask_b32 v117, v111, v110, vcc
    v_cmp_eq_u32 vcc, 3, v108
    s_nop 1
    v_cndmask_b32 v118, v111, v109, vcc
    v_cndmask_b32 v119, v111, v110, vcc
    s_waitcnt vmcnt(17)
    v_lshlrev_b32 v88, 16, v8
    v_and_b32 v89, s38, v8
    v_lshlrev_b32 v90, 16, v9
    v_and_b32 v91, s38, v9
    v_lshlrev_b32 v92, 16, v10
    v_and_b32 v93, s38, v10
    v_lshlrev_b32 v94, 16, v11
    v_and_b32 v95, s38, v11
    v_lshlrev_b32 v96, 16, v12
    v_and_b32 v97, s38, v12
    v_lshlrev_b32 v98, 16, v13
    v_and_b32 v99, s38, v13
    v_lshlrev_b32 v100, 16, v14
    v_and_b32 v101, s38, v14
    v_lshlrev_b32 v102, 16, v15
    v_and_b32 v103, s38, v15
    v_pk_add_f32 v[104:105], v[88:89], v[90:91]
    v_pk_add_f32 v[106:107], v[92:93], v[94:95]
    v_pk_add_f32 v[104:105], v[104:105], v[96:97]
    v_pk_add_f32 v[106:107], v[106:107], v[98:99]
    v_pk_add_f32 v[104:105], v[104:105], v[100:101]
    v_pk_add_f32 v[106:107], v[106:107], v[102:103]
    v_pk_add_f32 v[104:105], v[104:105], v[106:107]
    v_add_f32 v7, v104, v105
    s_nop 1
    v_add_f32_dpp v7, v7, v7 quad_perm:[1,0,3,2] row_mask:0xf bank_mask:0xf
    s_nop 1
    v_add_f32_dpp v7, v7, v7 quad_perm:[2,3,0,1] row_mask:0xf bank_mask:0xf
    s_nop 1
    v_add_f32_dpp v7, v7, v7 row_half_mirror row_mask:0xf bank_mask:0xf
    v_mov_b32 v104, v7
    s_nop 1
    v_permlane16_swap_b32 v7, v104
    v_add_f32 v7, v7, v104
    v_mov_b32 v104, v7
    s_nop 1
    v_permlane32_swap_b32 v7, v104
    v_add_f32 v7, v7, v104
    v_mul_f32 v7, 0x3b000000, v7
    v_sub_f32 v88, v88, v7
    v_sub_f32 v89, v89, v7
    v_sub_f32 v90, v90, v7
    v_sub_f32 v91, v91, v7
    v_sub_f32 v92, v92, v7
    v_sub_f32 v93, v93, v7
    v_sub_f32 v94, v94, v7
    v_sub_f32 v95, v95, v7
    v_sub_f32 v96, v96, v7
    v_sub_f32 v97, v97, v7
    v_sub_f32 v98, v98, v7
    v_sub_f32 v99, v99, v7
    v_sub_f32 v100, v100, v7
    v_sub_f32 v101, v101, v7
    v_sub_f32 v102, v102, v7
    v_sub_f32 v103, v103, v7
    v_pk_mul_f32 v[104:105], v[88:89], v[88:89]
    v_pk_mul_f32 v[106:107], v[90:91], v[90:91]
    v_pk_fma_f32 v[104:105], v[92:93], v[92:93], v[104:105]
    v_pk_fma_f32 v[106:107], v[94:95], v[94:95], v[106:107]
    v_pk_fma_f32 v[104:105], v[96:97], v[96:97], v[104:105]
    v_pk_fma_f32 v[106:107], v[98:99], v[98:99], v[106:107]
    v_pk_fma_f32 v[104:105], v[100:101], v[100:101], v[104:105]
    v_pk_fma_f32 v[106:107], v[102:103], v[102:103], v[106:107]
    v_pk_add_f32 v[104:105], v[104:105], v[106:107]
    v_add_f32 v108, v104, v105
    s_nop 1
    v_add_f32_dpp v108, v108, v108 quad_perm:[1,0,3,2] row_mask:0xf bank_mask:0xf
    s_nop 1
    v_add_f32_dpp v108, v108, v108 quad_perm:[2,3,0,1] row_mask:0xf bank_mask:0xf
    s_nop 1
    v_add_f32_dpp v108, v108, v108 row_half_mirror row_mask:0xf bank_mask:0xf
    v_mov_b32 v104, v108
    s_nop 1
    v_permlane16_swap_b32 v108, v104
    v_add_f32 v108, v108, v104
    v_mov_b32 v104, v108
    s_nop 1
    v_permlane32_swap_b32 v108, v104
    v_add_f32 v108, v108, v104
    v_mul_f32 v108, 0x3b000000, v108
    v_cvt_pk_bf16_f32 v108, 0, v108
    v_cvt_pk_bf16_f32 v120, 0, v7
    v_add_f32 v108, 0x3727c5ac, v108
    v_cvt_pk_bf16_f32 v108, 0, v108
    v_sqrt_f32 v108, v108
    s_nop 0
    v_cvt_pk_bf16_f32 v122, 0, v108
    v_rcp_f32 v124, v122
    s_waitcnt vmcnt(16)
    v_lshlrev_b32 v88, 16, v16
    v_and_b32 v89, s38, v16
    v_pk_add_f32 v[88:89], v[88:89], v[120:121] op_sel_hi:[1,0] neg_lo:[0,1] neg_hi:[0,1]
    v_cvt_pk_bf16_f32 v88, 0, v88
    v_cvt_pk_bf16_f32 v89, 0, v89
    v_pk_mul_f32 v[10:11], v[88:89], v[124:125] op_sel_hi:[1,0]
    v_pk_fma_f32 v[88:89], v[10:11], v[122:123], v[88:89] op_sel_hi:[1,0,1] neg_lo:[1,0,0] neg_hi:[1,0,0]
    v_pk_fma_f32 v[88:89], v[88:89], v[124:125], v[10:11] op_sel_hi:[1,0,1]
    v_cvt_pk_bf16_f32 v8, v88, v89
    s_waitcnt lgkmcnt(0)
    s_add_u32 s32, s32, 2654435769
    s_lshr_b32 s33, s32, 8
    s_lshr_b32 s34, s32, 16
    s_lshr_b32 s35, s32, 24
    s_mov_b32 s36, 0x0c0c0400
    s_mov_b32 s37, 0x04000c0c
    v_mov_b32_dpp v16, v8 row_newbcast:0 row_mask:0xf bank_mask:0x3
    v_mov_b32_dpp v17, v8 row_newbcast:1 row_mask:0xf bank_mask:0x3
    v_mov_b32_dpp v18, v8 row_newbcast:2 row_mask:0xf bank_mask:0x3
    v_mov_b32_dpp v19, v8 row_newbcast:3 row_mask:0xf bank_mask:0x3
    v_mov_b32_dpp v20, v8 row_newbcast:4 row_mask:0xf bank_mask:0x3
    v_mov_b32_dpp v21, v8 row_newbcast:5 row_mask:0xf bank_mask:0x3
    v_mov_b32_dpp v22, v8 row_newbcast:6 row_mask:0xf bank_mask:0x3
    v_mov_b32_dpp v23, v8 row_newbcast:7 row_mask:0xf bank_mask:0x3
    v_mov_b32_dpp v16, v8 row_newbcast:8 row_mask:0xf bank_mask:0xc
    v_mov_b32_dpp v17, v8 row_newbcast:9 row_mask:0xf bank_mask:0xc
    v_mov_b32_dpp v18, v8 row_newbcast:10 row_mask:0xf bank_mask:0xc
    v_mov_b32_dpp v19, v8 row_newbcast:11 row_mask:0xf bank_mask:0xc
    v_mov_b32_dpp v20, v8 row_newbcast:12 row_mask:0xf bank_mask:0xc
    v_mov_b32_dpp v21, v8 row_newbcast:13 row_mask:0xf bank_mask:0xc
    v_mov_b32_dpp v22, v8 row_newbcast:14 row_mask:0xf bank_mask:0xc
    v_mov_b32_dpp v23, v8 row_newbcast:15 row_mask:0xf bank_mask:0xc
    v_mov_b32 v100, 0xffffff00
    v_perm_b32 v88, v16, v16, v112
    v_perm_b32 v89, v16, v16, v114
    v_perm_b32 v90, v16, v16, v116
    v_perm_b32 v91, v16, v16, v118
    v_perm_b32 v92, v16, v16, v113
    v_perm_b32 v93, v16, v16, v115
    v_perm_b32 v94, v16, v16, v117
    v_perm_b32 v95, v16, v16, v119
    s_waitcnt vmcnt(15)
    v_mfma_f32_16x16x32_bf16 v[96:99], v[88:91], v[24:27], 0
    v_perm_b32 v88, v17, v17, v112
    v_perm_b32 v89, v17, v17, v114
    v_perm_b32 v90, v17, v17, v116
    v_perm_b32 v91, v17, v17, v118
    s_waitcnt vmcnt(14)
    v_mfma_f32_16x16x32_bf16 v[96:99], v[92:95], v[28:31], v[96:99]
    v_perm_b32 v92, v17, v17, v113
    v_perm_b32 v93, v17, v17, v115
    v_perm_b32 v94, v17, v17, v117
    v_perm_b32 v95, v17, v17, v119
    s_waitcnt vmcnt(13)
    v_mfma_f32_16x16x32_bf16 v[96:99], v[88:91], v[32:35], v[96:99]
    v_perm_b32 v88, v18, v18, v112
    v_perm_b32 v89, v18, v18, v114
    v_perm_b32 v90, v18, v18, v116
    v_perm_b32 v91, v18, v18, v118
    s_waitcnt vmcnt(12)
    v_mfma_f32_16x16x32_bf16 v[96:99], v[92:95], v[36:39], v[96:99]
    v_perm_b32 v92, v18, v18, v113
    v_perm_b32 v93, v18, v18, v115
    v_perm_b32 v94, v18, v18, v117
    v_perm_b32 v95, v18, v18, v119
    s_waitcnt vmcnt(11)
    v_mfma_f32_16x16x32_bf16 v[96:99], v[88:91], v[40:43], v[96:99]
    v_perm_b32 v88, v19, v19, v112
    v_perm_b32 v89, v19, v19, v114
    v_perm_b32 v90, v19, v19, v116
    v_perm_b32 v91, v19, v19, v118
    s_waitcnt vmcnt(10)
    v_mfma_f32_16x16x32_bf16 v[96:99], v[92:95], v[44:47], v[96:99]
    v_perm_b32 v92, v19, v19, v113
    v_perm_b32 v93, v19, v19, v115
    v_perm_b32 v94, v19, v19, v117
    v_perm_b32 v95, v19, v19, v119
    s_waitcnt vmcnt(9)
    v_mfma_f32_16x16x32_bf16 v[96:99], v[88:91], v[48:51], v[96:99]
    v_perm_b32 v88, v20, v20, v112
    v_perm_b32 v89, v20, v20, v114
    v_perm_b32 v90, v20, v20, v116
    v_perm_b32 v91, v20, v20, v118
    s_waitcnt vmcnt(8)
    v_mfma_f32_16x16x32_bf16 v[96:99], v[92:95], v[52:55], v[96:99]
    v_perm_b32 v92, v20, v20, v113
    v_perm_b32 v93, v20, v20, v115
    v_perm_b32 v94, v20, v20, v117
    v_perm_b32 v95, v20, v20, v119
    s_waitcnt vmcnt(7)
    v_mfma_f32_16x16x32_bf16 v[96:99], v[88:91], v[56:59], v[96:99]
    v_perm_b32 v88, v21, v21, v112
    v_perm_b32 v89, v21, v21, v114
    v_perm_b32 v90, v21, v21, v116
    v_perm_b32 v91, v21, v21, v118
    s_waitcnt vmcnt(6)
    v_mfma_f32_16x16x32_bf16 v[96:99], v[92:95], v[60:63], v[96:99]
    v_perm_b32 v92, v21, v21, v113
    v_perm_b32 v93, v21, v21, v115
    v_perm_b32 v94, v21, v21, v117
    v_perm_b32 v95, v21, v21, v119
    s_waitcnt vmcnt(5)
    v_mfma_f32_16x16x32_bf16 v[96:99], v[88:91], v[64:67], v[96:99]
    v_perm_b32 v88, v22, v22, v112
    v_perm_b32 v89, v22, v22, v114
    v_perm_b32 v90, v22, v22, v116
    v_perm_b32 v91, v22, v22, v118
    s_waitcnt vmcnt(4)
    v_mfma_f32_16x16x32_bf16 v[96:99], v[92:95], v[68:71], v[96:99]
    v_perm_b32 v92, v22, v22, v113
    v_perm_b32 v93, v22, v22, v115
    v_perm_b32 v94, v22, v22, v117
    v_perm_b32 v95, v22, v22, v119
    s_waitcnt vmcnt(3)
    v_mfma_f32_16x16x32_bf16 v[96:99], v[88:91], v[72:75], v[96:99]
    v_perm_b32 v88, v23, v23, v112
    v_perm_b32 v89, v23, v23, v114
    v_perm_b32 v90, v23, v23, v116
    v_perm_b32 v91, v23, v23, v118
    s_waitcnt vmcnt(2)
    v_mfma_f32_16x16x32_bf16 v[96:99], v[92:95], v[76:79], v[96:99]
    v_perm_b32 v92, v23, v23, v113
    v_perm_b32 v93, v23, v23, v115
    v_perm_b32 v94, v23, v23, v117
    v_perm_b32 v95, v23, v23, v119
    s_waitcnt vmcnt(1)
    v_mfma_f32_16x16x32_bf16 v[96:99], v[88:91], v[80:83], v[96:99]
    s_waitcnt vmcnt(0)
    v_mfma_f32_16x16x32_bf16 v[96:99], v[92:95], v[84:87], v[96:99]
    s_lshl_b32 s40, s29, 13
    s_lshl_b32 s41, s30, 9
    s_add_u32 s40, s40, s41
    s_add_u32 s40, s40, 4096
    v_and_b32 v4, 15, v1
    v_lshl_add_u32 v4, v4, 5, s40
    v_bfe_u32 v5, v1, 4, 1
    v_lshl_add_u32 v4, v5, 4, v4
    v_lshrrev_b32 v5, 5, v1
    v_lshl_add_u32 v4, v5, 12, v4
    s_getreg_b32 s42, hwreg(HW_REG_XCC_ID, 0, 4)
    s_and_b32 s43, s32, 0xffffff00
    s_or_b32 s42, s42, s43
    s_lshl_b32 s40, s28, 7
    s_add_u32 s40, s40, 1024
    v_add_u32 v96, 0x80, v96
    v_add_u32 v97, 0x80, v97
    v_add_u32 v98, 0x80, v98
    v_add_u32 v99, 0x80, v99
    v_bfi_b32 v96, v100, v96, s32
    v_bfi_b32 v97, v100, v97, s33
    v_bfi_b32 v98, v100, v98, s34
    v_bfi_b32 v99, v100, v99, s35
    global_store_dwordx4 v4, v[96:99], s[26:27] sc1
    v_and_b32 v5, 31, v1
    v_lshl_add_u32 v5, v5, 2, s40
    s_lshl_b32 s40, s29, 13
    s_lshr_b32 s41, s30, 2
    s_lshl_b32 s41, s41, 12
    s_add_u32 s40, s40, s41
    s_add_u32 s40, s40, 4096
    v_lshl_add_u32 v4, v1, 4, s40
    s_barrier
    s_barrier
    s_mov_b32 s39, 0
    global_load_dwordx4 v[8:11], v4, s[26:27] offset:0 sc1
    global_load_dwordx4 v[12:15], v4, s[26:27] offset:1024 sc1
    global_load_dwordx4 v[16:19], v4, s[26:27] offset:2048 sc1
    global_load_dwordx4 v[20:23], v4, s[26:27] offset:3072 sc1
    global_load_dword v32, v5, s[26:27] sc1
    s_lshl_b32 s40, s29, 12
    s_lshl_b32 s41, s30, 9
    s_add_u32 s40, s40, s41
    s_add_u32 s40, s40, 327680
    v_and_b32 v33, 7, v1
    v_lshl_add_u32 v33, v33, 6, s40
    global_load_dword v34, v33, s[26:27] sc1
    s_barrier
    s_branch L_poll1w
L_poll1:
    global_load_dwordx4 v[8:11], v4, s[26:27] offset:0 sc1
    global_load_dwordx4 v[12:15], v4, s[26:27] offset:1024 sc1
    global_load_dwordx4 v[16:19], v4, s[26:27] offset:2048 sc1
    global_load_dwordx4 v[20:23], v4, s[26:27] offset:3072 sc1
    global_load_dword v32, v5, s[26:27] sc1
    s_add_u32 s39, s39, 1
    s_cmp_gt_u32 s39, 524288
    s_cbranch_scc1 L_bail
L_poll1w:
    s_waitcnt vmcnt(0)
L_poll1c:
    v_perm_b32 v24, v9, v8, s36
    v_perm_b32 v25, v11, v10, s37
    v_perm_b32 v26, v13, v12, s36
    v_perm_b32 v27, v15, v14, s37
    v_perm_b32 v28, v17, v16, s36
    v_perm_b32 v29, v19, v18, s37
    v_perm_b32 v30, v21, v20, s36
    v_perm_b32 v31, v23, v22, s37
    v_bitop3_b32 v24, v24, v25, s32 bitop3:0x56
    v_bitop3_b32 v26, v26, v27, s32 bitop3:0x56
    v_bitop3_b32 v28, v28, v29, s32 bitop3:0x56
    v_bitop3_b32 v30, v30, v31, s32 bitop3:0x56
    v_or3_b32 v24, v24, v26, v28
    v_or_b32 v24, v24, v30
    v_cmp_ne_u32 vcc, 0, v24
    s_cbranch_vccnz L_poll1
L_qok:
    v_cmp_ne_u32 vcc, s42, v32
    v_and_b32 v8, v100, v8
    v_and_b32 v9, v100, v9
    v_and_b32 v10, v100, v10
    v_and_b32 v11, v100, v11
    v_and_b32 v12, v100, v12
    v_and_b32 v13, v100, v13
    v_and_b32 v14, v100, v14
    v_and_b32 v15, v100, v15
    v_and_b32 v16, v100, v16
    v_and_b32 v17, v100, v17
    v_and_b32 v18, v100, v18
    v_and_b32 v19, v100, v19
    v_and_b32 v20, v100, v20
    v_and_b32 v21, v100, v21
    v_and_b32 v22, v100, v22
    v_and_b32 v23, v100, v23
    s_cmp_eq_u64 vcc, 0
    s_cselect_b32 s40, 3, 1
    v_add_f32 v8, v8, v12
    v_add_f32 v16, v16, v20
    v_add_f32 v9, v9, v13
    v_add_f32 v17, v17, v21
    v_add_f32 v10, v10, v14
    v_add_f32 v18, v18, v22
    v_add_f32 v11, v11, v15
    v_add_f32 v19, v19, v23
    v_add_f32 v8, v8, v16
    v_add_f32 v9, v9, v17
    v_add_f32 v10, v10, v18
    v_add_f32 v11, v11, v19
    s_nop 0
    v_permlane32_swap_b32 v8, v10
    v_permlane32_swap_b32 v9, v11
    v_add_f32 v8, v8, v10
    v_add_f32 v9, v9, v11
    v_cvt_pk_bf16_f32 v8, v8, v9
    v_and_b32 v4, 31, v1
    v_lshlrev_b32 v4, 3, v4
    v_lshrrev_b32 v5, 5, v1
    v_lshl_add_u32 v4, v5, 2, v4
    v_mov_b32 v6, 364
    v_mov_b32 v7, s40
    s_mov_b32 s54, s40
    ds_write_b32 v4, v8 offset:0
    s_mov_b64 exec, 1
    ds_max_u32 v6, v7 offset:20
    ds_max_u32 v6, v7
    s_mov_b64 exec, -1
L_cafter:
    s_setprio 0
    s_and_b32 s40, s29, 3
    s_lshl_b32 s48, s40, 2
    s_lshr_b32 s40, s30, 2
    s_lshl_b32 s40, s40, 1
    s_add_u32 s48, s48, s40
    s_and_b32 s40, s30, 1
    s_add_u32 s48, s48, s40
    s_bitcmp0_b32 s30, 1
    s_cbranch_scc1 L_cwo
    s_cmp_lt_u32 s48, 8
    s_cbranch_scc1 L_chelp
    s_sub_u32 s40, s48, 8
    s_min_u32 s41, s28, 3
    s_mul_i32 s48, s28, 5
    s_add_u32 s48, s48, s41
    s_add_u32 s48, s48, s40
    s_cmp_lt_u32 s28, 3
    s_cselect_b32 s41, 6, 5
    s_cmp_lt_u32 s40, s41
    s_cbranch_scc1 L_cffn
    s_branch L_cmon
L_cwo:
    s_lshl_b32 s40, s28, 19
    s_lshl_b32 s41, s48, 6
    s_add_u32 s41, s40, s41
    v_lshrrev_b32 v4, 2, v1
    v_lshlrev_b32 v4, 10, v4
    v_and_b32 v5, 3, v1
    v_lshl_add_u32 v4, v5, 4, v4
    v_add_u32 v8, s41, v4
    v_add_u32 v9, 16384, v8
    v_add_u32 v10, 32768, v8
    v_add_u32 v11, 49152, v8
    v_add_u32 v12, 65536, v8
    v_add_u32 v13, 81920, v8
    v_add_u32 v14, 98304, v8
    v_add_u32 v15, 114688, v8
    v_add_u32 v16, 131072, v8
    v_add_u32 v17, 147456, v8
    v_add_u32 v18, 163840, v8
    v_add_u32 v19, 180224, v8
    v_add_u32 v20, 196608, v8
    v_add_u32 v21, 212992, v8
    v_add_u32 v22, 229376, v8
    v_add_u32 v23, 245760, v8
    v_add_u32 v24, 262144, v8
    v_add_u32 v25, 278528, v8
    v_add_u32 v26, 294912, v8
    v_add_u32 v27, 311296, v8
    v_add_u32 v28, 327680, v8
    v_add_u32 v29, 344064, v8
    v_add_u32 v30, 360448, v8
    v_add_u32 v31, 376832, v8
    v_add_u32 v32, 393216, v8
    v_add_u32 v33, 409600, v8
    v_add_u32 v34, 425984, v8
    v_add_u32 v35, 442368, v8
    v_add_u32 v36, 458752, v8
    v_add_u32 v37, 475136, v8
    v_add_u32 v38, 491520, v8
    v_add_u32 v39, 507904, v8
    s_lshl_b32 s41, s48, 14
    s_add_u32 s40, s40, s41
    s_add_u32 s40, s40, 4096
    v_lshl_add_u32 v4, v1, 6, s40
    v_add_u32 v5, 0x2000, v4
    v_mov_b32 v6, 356
    s_mov_b32 s39, 0
L_lw2:
    ds_read_b32 v7, v6
    s_add_u32 s39, s39, 1
    s_cmp_gt_u32 s39, 4194304
    s_cbranch_scc1 L_bail
    s_waitcnt lgkmcnt(0)
    v_readfirstlane_b32 s40, v7
    s_nop 0
    s_cmp_ge_u32 s40, s55
    s_cbranch_scc1 L_lw2d
    s_sleep 1
    s_branch L_lw2
L_lw2d:
    global_load_dword v40, v4, s[12:13] offset:-4096
    global_load_dword v41, v4, s[12:13] offset:0
    global_load_dword v42, v5, s[12:13] offset:-4096
    global_load_dword v43, v5, s[12:13] offset:0
    s_mov_b32 m0, 32512
    s_nop 0
    global_load_lds_dwordx4 v24, s[12:13] nt
    s_mov_b32 m0, 33568
    s_nop 0
    global_load_lds_dwordx4 v25, s[12:13] nt
    s_mov_b32 m0, 34624
    s_nop 0
    global_load_lds_dwordx4 v26, s[12:13] nt
    s_mov_b32 m0, 35680
    s_nop 0
    global_load_lds_dwordx4 v27, s[12:13] nt
    s_mov_b32 m0, 36736
    s_nop 0
    global_load_lds_dwordx4 v28, s[12:13] nt
    s_mov_b32 m0, 37792
    s_nop 0
    global_load_lds_dwordx4 v29, s[12:13] nt
    s_mov_b32 m0, 38848
    s_nop 0
    global_load_lds_dwordx4 v30, s[12:13] nt
    s_mov_b32 m0, 39904
    s_nop 0
    global_load_lds_dwordx4 v31, s[12:13] nt
    s_mov_b32 m0, 40960
    s_waitcnt vmcnt(15)
    global_load_lds_dwordx4 v32, s[12:13] nt
    s_mov_b32 m0, 42016
    s_waitcnt vmcnt(15)
    global_load_lds_dwordx4 v33, s[12:13] nt
    s_mov_b32 m0, 43072
    s_waitcnt vmcnt(15)
    global_load_lds_dwordx4 v34, s[12:13] nt
    s_mov_b32 m0, 44128
    s_waitcnt vmcnt(15)
    global_load_lds_dwordx4 v35, s[12:13] nt
    s_mov_b32 m0, 45184
    s_waitcnt vmcnt(15)
    global_load_lds_dwordx4 v36, s[12:13] nt
    s_mov_b32 m0, 46240
    s_waitcnt vmcnt(15)
    global_load_lds_dwordx4 v37, s[12:13] nt
    s_mov_b32 m0, 47296
    s_waitcnt vmcnt(15)
    global_load_lds_dwordx4 v38, s[12:13] nt
    s_mov_b32 m0, 48352
    s_waitcnt vmcnt(15)
    global_load_lds_dwordx4 v39, s[12:13] nt
    s_mov_b32 m0, 15616
    s_waitcnt vmcnt(15)
    global_load_lds_dwordx4 v8, s[12:13] nt
    s_mov_b32 m0, 16672
    s_waitcnt vmcnt(15)
    global_load_lds_dwordx4 v9, s[12:13] nt
    s_mov_b32 m0, 17728
    s_waitcnt vmcnt(15)
    global_load_lds_dwordx4 v10, s[12:13] nt
    s_mov_b32 m0, 18784
    s_waitcnt vmcnt(15)
    global_load_lds_dwordx4 v11, s[12:13] nt
    s_mov_b32 m0, 19840
    s_waitcnt vmcnt(15)
    global_load_lds_dwordx4 v12, s[12:13] nt
    s_mov_b32 m0, 20896
    s_waitcnt vmcnt(15)
    global_load_lds_dwordx4 v13, s[12:13] nt
    s_mov_b32 m0, 21952
    s_waitcnt vmcnt(15)
    global_load_lds_dwordx4 v14, s[12:13] nt
    s_mov_b32 m0, 23008
    s_waitcnt vmcnt(15)
    global_load_lds_dwordx4 v15, s[12:13] nt
    s_mov_b32 m0, 24064
    s_waitcnt vmcnt(15)
    global_load_lds_dwordx4 v16, s[12:13] nt
    s_mov_b32 m0, 25120
    s_waitcnt vmcnt(15)
    global_load_lds_dwordx4 v17, s[12:13] nt
    s_mov_b32 m0, 26176
    s_waitcnt vmcnt(15)
    global_load_lds_dwordx4 v18, s[12:13] nt
    s_mov_b32 m0, 27232
    s_waitcnt vmcnt(15)
    global_load_lds_dwordx4 v19, s[12:13] nt
    s_mov_b32 m0, 28288
    s_waitcnt vmcnt(15)
    global_load_lds_dwordx4 v20, s[12:13] nt
    s_mov_b32 m0, 29344
    s_waitcnt vmcnt(15)
    global_load_lds_dwordx4 v21, s[12:13] nt
    s_mov_b32 m0, 30400
    s_waitcnt vmcnt(15)
    global_load_lds_dwordx4 v22, s[12:13] nt
    s_mov_b32 m0, 31456
    s_waitcnt vmcnt(15)
    global_load_lds_dwordx4 v23, s[12:13] nt
    v_mov_b32 v6, 372
    v_mov_b32 v7, 1
    s_waitcnt vmcnt(0)
    ds_write_b32 v6, v7
    s_endpgm
L_chelp:
    s_min_u32 s41, s28, 3
    s_mul_i32 s42, s28, 5
    s_add_u32 s42, s42, s41
    s_and_b32 s40, s48, 3
    s_mul_i32 s41, s40, 32
    s_lshr_b32 s40, s48, 2
    s_lshl_b32 s40, s40, 8
    s_add_u32 s41, s41, s40
    s_add_u32 s41, s41, 128
    s_mul_i32 s41, s41, 2752
    s_lshl_b32 s40, s42, 6
    s_add_u32 s41, s41, s40
    v_lshrrev_b32 v8, 2, v1
    v_mul_u32_u24 v8, 2752, v8
    v_and_b32 v5, 3, v1
    v_lshlrev_b32 v5, 7, v5
    v_min_u32 v5, 380, v5
    v_add_u32 v8, v5, v8
    v_add_u32 v8, s41, v8
    v_add_u32 v9, 44032, v8
    v_min_u32 v9, 1409020, v9
    v_add_u32 v8, 0, v8
    v_min_u32 v8, 1409020, v8
    s_lshl_b32 s42, s42, 15
    s_mul_i32 s40, s48, 24576
    s_add_u32 s42, s42, s40
    v_lshl_add_u32 v20, v1, 7, s42
    v_add_u32 v22, 16384, v20
    v_min_u32 v22, 1409020, v22
    v_add_u32 v21, 8192, v20
    v_min_u32 v21, 1409020, v21
    v_add_u32 v20, 0, v20
    v_min_u32 v20, 1409020, v20
    s_lshl_b32 s41, s28, 19
    s_mul_i32 s42, s48, 32768
    s_add_u32 s41, s41, s42
    s_add_u32 s41, s41, 0x40000
    v_lshl_add_u32 v4, v1, 7, s41
    s_movk_i32 s43, 0x2000
    v_mov_b32 v6, 356
    s_mov_b32 s39, 0
L_lw3:
    ds_read_b32 v7, v6
    s_add_u32 s39, s39, 1
    s_cmp_gt_u32 s39, 4194304
    s_cbranch_scc1 L_bail
    s_waitcnt lgkmcnt(0)
    v_readfirstlane_b32 s40, v7
    s_nop 0
    s_cmp_ge_u32 s40, s55
    s_cbranch_scc1 L_lw3d
    s_sleep 1
    s_branch L_lw3
L_lw3d:
    global_load_dword v48, v4, s[12:13]
    v_add_u32 v4, s43, v4
    global_load_dword v49, v4, s[12:13]
    v_add_u32 v4, s43, v4
    global_load_dword v50, v4, s[12:13]
    v_add_u32 v4, s43, v4
    global_load_dword v51, v4, s[12:13]
    v_add_u32 v4, s43, v4
    s_waitcnt vmcnt(3)
    global_load_dword v56, v8, s[16:17]
    s_waitcnt vmcnt(3)
    global_load_dword v57, v8, s[18:19]
    s_waitcnt vmcnt(3)
    global_load_dword v58, v9, s[16:17]
    s_waitcnt vmcnt(3)
    global_load_dword v59, v9, s[18:19]
    s_waitcnt vmcnt(3)
    global_load_dword v40, v20, s[20:21]
    s_waitcnt vmcnt(3)
    global_load_dword v41, v21, s[20:21]
    s_waitcnt vmcnt(3)
    global_load_dword v42, v22, s[20:21]
    s_endpgm
L_cffn:
    v_lshrrev_b32 v4, 2, v1
    v_mul_u32_u24 v4, 2752, v4
    v_and_b32 v5, 3, v1
    v_lshl_add_u32 v4, v5, 4, v4
    s_lshl_b32 s40, s48, 6
    v_add_u32 v8, s40, v4
    s_and_b32 s43, s48, 1
    s_mul_i32 s41, s43, 704512
    v_add_u32 v8, s41, v8
    s_lshl_b32 s41, s41, 1
    s_sub_u32 s41, 704512, s41
    v_add_u32 v24, s41, v8
    s_mul_i32 s43, s43, 16896
    s_sub_u32 s42, 32512, s43
    s_add_u32 s43, s43, 15616
    v_add_u32 v9, 44032, v8
    v_add_u32 v25, 44032, v24
    v_add_u32 v10, 88064, v8
    v_add_u32 v26, 88064, v24
    v_add_u32 v11, 132096, v8
    v_add_u32 v27, 132096, v24
    v_add_u32 v12, 176128, v8
    v_add_u32 v28, 176128, v24
    v_add_u32 v13, 220160, v8
    v_add_u32 v29, 220160, v24
    v_add_u32 v14, 264192, v8
    v_add_u32 v30, 264192, v24
    v_add_u32 v15, 308224, v8
    v_add_u32 v31, 308224, v24
    v_add_u32 v16, 352256, v8
    v_add_u32 v32, 352256, v24
    v_add_u32 v17, 396288, v8
    v_add_u32 v33, 396288, v24
    v_add_u32 v18, 440320, v8
    v_add_u32 v34, 440320, v24
    v_add_u32 v19, 484352, v8
    v_add_u32 v35, 484352, v24
    v_add_u32 v20, 528384, v8
    v_add_u32 v36, 528384, v24
    v_add_u32 v21, 572416, v8
    v_add_u32 v37, 572416, v24
    v_add_u32 v22, 616448, v8
    v_add_u32 v38, 616448, v24
    v_add_u32 v23, 660480, v8
    v_add_u32 v39, 660480, v24
    s_lshl_b32 s40, s48, 15
    s_add_u32 s40, s40, 4096
    v_lshl_add_u32 v40, v1, 4, s40
    v_add_u32 v41, 8192, v40
    v_add_u32 v42, 16384, v40
    v_add_u32 v43, 24576, v40
    v_mov_b32 v4, 376
    s_mov_b32 s96, 0
    v_mov_b32 v6, 356
    s_mov_b32 s39, 0
L_lw4:
    ds_read_b32 v7, v6
    s_add_u32 s39, s39, 1
    s_cmp_gt_u32 s39, 4194304
    s_cbranch_scc1 L_bail
    s_waitcnt lgkmcnt(0)
    v_readfirstlane_b32 s40, v7
    s_nop 0
    s_cmp_ge_u32 s40, s55
    s_cbranch_scc1 L_lw4d
    s_sleep 1
    s_branch L_lw4
L_lw4d:
    ds_read_b32 v5, v4
    s_add_u32 m0, s43, 0
    s_nop 0
    global_load_lds_dwordx4 v8, s[16:17]
    s_add_u32 m0, s43, 33808
    s_nop 0
    global_load_lds_dwordx4 v8, s[18:19]
    s_add_u32 m0, s43, 1056
    s_nop 0
    global_load_lds_dwordx4 v9, s[16:17]
    s_add_u32 m0, s43, 34864
    s_nop 0
    global_load_lds_dwordx4 v9, s[18:19]
    s_add_u32 m0, s43, 2112
    s_nop 0
    global_load_lds_dwordx4 v10, s[16:17]
    s_add_u32 m0, s43, 35920
    s_nop 0
    global_load_lds_dwordx4 v10, s[18:19]
    s_add_u32 m0, s43, 3168
    s_nop 0
    global_load_lds_dwordx4 v11, s[16:17]
    s_add_u32 m0, s43, 36976
    s_nop 0
    global_load_lds_dwordx4 v11, s[18:19]
    s_waitcnt lgkmcnt(0)
    v_readfirstlane_b32 s40, v5
    s_nop 0
    s_add_u32 s40, s40, 1
    s_lshr_b32 s40, s40, 4
    s_andn2_b32 s40, s40, s96
    s_cbranch_scc0 L_cf8
    s_mov_b32 s96, 1
    s_barrier
    v_mov_b32 v6, 380
    s_mov_b32 s39, 0
L_lw5:
    ds_read_b32 v7, v6
    s_add_u32 s39, s39, 1
    s_cmp_gt_u32 s39, 4194304
    s_cbranch_scc1 L_bail
    s_waitcnt lgkmcnt(0)
    v_readfirstlane_b32 s40, v7
    s_nop 0
    s_cmp_ge_u32 s40, 8
    s_cbranch_scc1 L_lw5d
    s_sleep 1
    s_branch L_lw5
L_lw5d:
L_cf8:
    ds_read_b32 v5, v4
    s_add_u32 m0, s43, 4224
    s_nop 0
    global_load_lds_dwordx4 v12, s[16:17]
    s_add_u32 m0, s43, 38032
    s_nop 0
    global_load_lds_dwordx4 v12, s[18:19]
    s_add_u32 m0, s43, 5280
    s_nop 0
    global_load_lds_dwordx4 v13, s[16:17]
    s_add_u32 m0, s43, 39088
    s_nop 0
    global_load_lds_dwordx4 v13, s[18:19]
    s_add_u32 m0, s43, 6336
    s_waitcnt vmcnt(11)
    global_load_lds_dwordx4 v14, s[16:17]
    s_add_u32 m0, s43, 40144
    s_waitcnt vmcnt(11)
    global_load_lds_dwordx4 v14, s[18:19]
    s_add_u32 m0, s43, 7392
    s_waitcnt vmcnt(11)
    global_load_lds_dwordx4 v15, s[16:17]
    s_add_u32 m0, s43, 41200
    s_waitcnt vmcnt(11)
    global_load_lds_dwordx4 v15, s[18:19]
    s_waitcnt lgkmcnt(0)
    v_readfirstlane_b32 s40, v5
    s_nop 0
    s_add_u32 s40, s40, 1
    s_lshr_b32 s40, s40, 4
    s_andn2_b32 s40, s40, s96
    s_cbranch_scc0 L_cf16
    s_mov_b32 s96, 1
    s_barrier
    v_mov_b32 v6, 380
    s_mov_b32 s39, 0
L_lw6:
    ds_read_b32 v7, v6
    s_add_u32 s39, s39, 1
    s_cmp_gt_u32 s39, 4194304
    s_cbranch_scc1 L_bail
    s_waitcnt lgkmcnt(0)
    v_readfirstlane_b32 s40, v7
    s_nop 0
    s_cmp_ge_u32 s40, 8
    s_cbranch_scc1 L_lw6d
    s_sleep 1
    s_branch L_lw6
L_lw6d:
L_cf16:
    ds_read_b32 v5, v4
    s_add_u32 m0, s43, 8448
    s_waitcnt vmcnt(11)
    global_load_lds_dwordx4 v16, s[16:17]
    s_add_u32 m0, s43, 42256
    s_waitcnt vmcnt(11)
    global_load_lds_dwordx4 v16, s[18:19]
    s_add_u32 m0, s43, 9504
    s_waitcnt vmcnt(11)
    global_load_lds_dwordx4 v17, s[16:17]
    s_add_u32 m0, s43, 43312
    s_waitcnt vmcnt(11)
    global_load_lds_dwordx4 v17, s[18:19]
    s_add_u32 m0, s43, 10560
    s_waitcnt vmcnt(11)
    global_load_lds_dwordx4 v18, s[16:17]
    s_add_u32 m0, s43, 44368
    s_waitcnt vmcnt(11)
    global_load_lds_dwordx4 v18, s[18:19]
    s_add_u32 m0, s43, 11616
    s_waitcnt vmcnt(11)
    global_load_lds_dwordx4 v19, s[16:17]
    s_add_u32 m0, s43, 45424
    s_waitcnt vmcnt(11)
    global_load_lds_dwordx4 v19, s[18:19]
    s_waitcnt lgkmcnt(0)
    v_readfirstlane_b32 s40, v5
    s_nop 0
    s_add_u32 s40, s40, 1
    s_lshr_b32 s40, s40, 4
    s_andn2_b32 s40, s40, s96
    s_cbranch_scc0 L_cf24
    s_mov_b32 s96, 1
    s_barrier
    v_mov_b32 v6, 380
    s_mov_b32 s39, 0
L_lw7:
    ds_read_b32 v7, v6
    s_add_u32 s39, s39, 1
    s_cmp_gt_u32 s39, 4194304
    s_cbranch_scc1 L_bail
    s_waitcnt lgkmcnt(0)
    v_readfirstlane_b32 s40, v7
    s_nop 0
    s_cmp_ge_u32 s40, 8
    s_cbranch_scc1 L_lw7d
    s_sleep 1
    s_branch L_lw7
L_lw7d:
L_cf24:
    ds_read_b32 v5, v4
    s_add_u32 m0, s43, 12672
    s_nop 0
    global_load_lds_dwordx4 v20, s[16:17]
    s_add_u32 m0, s43, 46480
    s_nop 0
    global_load_lds_dwordx4 v20, s[18:19]
    s_add_u32 m0, s43, 13728
    s_nop 0
    global_load_lds_dwordx4 v21, s[16:17]
    s_add_u32 m0, s43, 47536
    s_nop 0
    global_load_lds_dwordx4 v21, s[18:19]
    s_add_u32 m0, s43, 14784
    s_nop 0
    global_load_lds_dwordx4 v22, s[16:17]
    s_add_u32 m0, s43, 48592
    s_nop 0
    global_load_lds_dwordx4 v22, s[18:19]
    s_add_u32 m0, s43, 15840
    s_nop 0
    global_load_lds_dwordx4 v23, s[16:17]
    s_add_u32 m0, s43, 49648
    s_nop 0
    global_load_lds_dwordx4 v23, s[18:19]
    s_waitcnt lgkmcnt(0)
    v_readfirstlane_b32 s40, v5
    s_nop 0
    s_add_u32 s40, s40, 1
    s_lshr_b32 s40, s40, 4
    s_andn2_b32 s40, s40, s96
    s_cbranch_scc0 L_cf32
    s_mov_b32 s96, 1
    s_barrier
    v_mov_b32 v6, 380
    s_mov_b32 s39, 0
L_lw8:
    ds_read_b32 v7, v6
    s_add_u32 s39, s39, 1
    s_cmp_gt_u32 s39, 4194304
    s_cbranch_scc1 L_bail
    s_waitcnt lgkmcnt(0)
    v_readfirstlane_b32 s40, v7
    s_nop 0
    s_cmp_ge_u32 s40, 8
    s_cbranch_scc1 L_lw8d
    s_sleep 1
    s_branch L_lw8
L_lw8d:
L_cf32:
    ds_read_b32 v5, v4
    s_add_u32 m0, s42, 0
    s_nop 0
    global_load_lds_dwordx4 v24, s[16:17]
    s_add_u32 m0, s42, 33808
    s_waitcnt vmcnt(32)
    global_load_lds_dwordx4 v24, s[18:19]
    s_add_u32 m0, s42, 1056
    s_waitcnt vmcnt(32)
    global_load_lds_dwordx4 v25, s[16:17]
    s_add_u32 m0, s42, 34864
    s_waitcnt vmcnt(32)
    global_load_lds_dwordx4 v25, s[18:19]
    s_add_u32 m0, s42, 2112
    s_waitcnt vmcnt(32)
    global_load_lds_dwordx4 v26, s[16:17]
    s_add_u32 m0, s42, 35920
    s_waitcnt vmcnt(32)
    global_load_lds_dwordx4 v26, s[18:19]
    s_add_u32 m0, s42, 3168
    s_waitcnt vmcnt(32)
    global_load_lds_dwordx4 v27, s[16:17]
    s_add_u32 m0, s42, 36976
    s_waitcnt vmcnt(32)
    global_load_lds_dwordx4 v27, s[18:19]
    s_waitcnt lgkmcnt(0)
    v_readfirstlane_b32 s40, v5
    s_nop 0
    s_add_u32 s40, s40, 1
    s_lshr_b32 s40, s40, 4
    s_andn2_b32 s40, s40, s96
    s_cbranch_scc0 L_cf40
    s_mov_b32 s96, 1
    s_barrier
    v_mov_b32 v6, 380
    s_mov_b32 s39, 0
L_lw9:
    ds_read_b32 v7, v6
    s_add_u32 s39, s39, 1
    s_cmp_gt_u32 s39, 4194304
    s_cbranch_scc1 L_bail
    s_waitcnt lgkmcnt(0)
    v_readfirstlane_b32 s40, v7
    s_nop 0
    s_cmp_ge_u32 s40, 8
    s_cbranch_scc1 L_lw9d
    s_sleep 1
    s_branch L_lw9
L_lw9d:
L_cf40:
    ds_read_b32 v5, v4
    s_add_u32 m0, s42, 4224
    s_waitcnt vmcnt(32)
    global_load_lds_dwordx4 v28, s[16:17]
    s_add_u32 m0, s42, 38032
    s_waitcnt vmcnt(32)
    global_load_lds_dwordx4 v28, s[18:19]
    s_add_u32 m0, s42, 5280
    s_waitcnt vmcnt(32)
    global_load_lds_dwordx4 v29, s[16:17]
    s_add_u32 m0, s42, 39088
    s_waitcnt vmcnt(32)
    global_load_lds_dwordx4 v29, s[18:19]
    s_add_u32 m0, s42, 6336
    s_waitcnt vmcnt(32)
    global_load_lds_dwordx4 v30, s[16:17]
    s_add_u32 m0, s42, 40144
    s_waitcnt vmcnt(32)
    global_load_lds_dwordx4 v30, s[18:19]
    s_add_u32 m0, s42, 7392
    s_waitcnt vmcnt(32)
    global_load_lds_dwordx4 v31, s[16:17]
    s_add_u32 m0, s42, 41200
    s_waitcnt vmcnt(32)
    global_load_lds_dwordx4 v31, s[18:19]
    s_waitcnt lgkmcnt(0)
    v_readfirstlane_b32 s40, v5
    s_nop 0
    s_add_u32 s40, s40, 1
    s_lshr_b32 s40, s40, 4
    s_andn2_b32 s40, s40, s96
    s_cbranch_scc0 L_cf48
    s_mov_b32 s96, 1
    s_barrier
    v_mov_b32 v6, 380
    s_mov_b32 s39, 0
L_lw10:
    ds_read_b32 v7, v6
    s_add_u32 s39, s39, 1
    s_cmp_gt_u32 s39, 4194304
    s_cbranch_scc1 L_bail
    s_waitcnt lgkmcnt(0)
    v_readfirstlane_b32 s40, v7
    s_nop 0
    s_cmp_ge_u32 s40, 8
    s_cbranch_scc1 L_lw10d
    s_sleep 1
    s_branch L_lw10
L_lw10d:
L_cf48:
    ds_read_b32 v5, v4
    s_add_u32 m0, s42, 8448
    s_waitcnt vmcnt(32)
    global_load_lds_dwordx4 v32, s[16:17]
    s_add_u32 m0, s42, 42256
    s_waitcnt vmcnt(32)
    global_load_lds_dwordx4 v32, s[18:19]
    s_add_u32 m0, s42, 9504
    s_waitcnt vmcnt(32)
    global_load_lds_dwordx4 v33, s[16:17]
    s_add_u32 m0, s42, 43312
    s_waitcnt vmcnt(32)
    global_load_lds_dwordx4 v33, s[18:19]
    s_add_u32 m0, s42, 10560
    s_waitcnt vmcnt(32)
    global_load_lds_dwordx4 v34, s[16:17]
    s_add_u32 m0, s42, 44368
    s_waitcnt vmcnt(32)
    global_load_lds_dwordx4 v34, s[18:19]
    s_add_u32 m0, s42, 11616
    s_waitcnt vmcnt(32)
    global_load_lds_dwordx4 v35, s[16:17]
    s_add_u32 m0, s42, 45424
    s_waitcnt vmcnt(32)
    global_load_lds_dwordx4 v35, s[18:19]
    s_waitcnt lgkmcnt(0)
    v_readfirstlane_b32 s40, v5
    s_nop 0
    s_add_u32 s40, s40, 1
    s_lshr_b32 s40, s40, 4
    s_andn2_b32 s40, s40, s96
    s_cbranch_scc0 L_cf56
    s_mov_b32 s96, 1
    s_barrier
    v_mov_b32 v6, 380
    s_mov_b32 s39, 0
L_lw11:
    ds_read_b32 v7, v6
    s_add_u32 s39, s39, 1
    s_cmp_gt_u32 s39, 4194304
    s_cbranch_scc1 L_bail
    s_waitcnt lgkmcnt(0)
    v_readfirstlane_b32 s40, v7
    s_nop 0
    s_cmp_ge_u32 s40, 8
    s_cbranch_scc1 L_lw11d
    s_sleep 1
    s_branch L_lw11
L_lw11d:
L_cf56:
    ds_read_b32 v5, v4
    s_add_u32 m0, s42, 12672
    s_waitcnt vmcnt(32)
    global_load_lds_dwordx4 v36, s[16:17]
    s_add_u32 m0, s42, 46480
    s_waitcnt vmcnt(32)
    global_load_lds_dwordx4 v36, s[18:19]
    s_add_u32 m0, s42, 13728
    s_waitcnt vmcnt(32)
    global_load_lds_dwordx4 v37, s[16:17]
    s_add_u32 m0, s42, 47536
    s_waitcnt vmcnt(32)
    global_load_lds_dwordx4 v37, s[18:19]
    s_add_u32 m0, s42, 14784
    s_waitcnt vmcnt(32)
    global_load_lds_dwordx4 v38, s[16:17]
    s_add_u32 m0, s42, 48592
    s_waitcnt vmcnt(32)
    global_load_lds_dwordx4 v38, s[18:19]
    s_add_u32 m0, s42, 15840
    s_waitcnt vmcnt(32)
    global_load_lds_dwordx4 v39, s[16:17]
    s_add_u32 m0, s42, 49648
    s_waitcnt vmcnt(32)
    global_load_lds_dwordx4 v39, s[18:19]
    s_waitcnt lgkmcnt(0)
    v_readfirstlane_b32 s40, v5
    s_nop 0
    s_add_u32 s40, s40, 1
    s_lshr_b32 s40, s40, 4
    s_andn2_b32 s40, s40, s96
    s_cbranch_scc0 L_cf64
    s_mov_b32 s96, 1
    s_barrier
    v_mov_b32 v6, 380
    s_mov_b32 s39, 0
L_lw12:
    ds_read_b32 v7, v6
    s_add_u32 s39, s39, 1
    s_cmp_gt_u32 s39, 4194304
    s_cbranch_scc1 L_bail
    s_waitcnt lgkmcnt(0)
    v_readfirstlane_b32 s40, v7
    s_nop 0
    s_cmp_ge_u32 s40, 8
    s_cbranch_scc1 L_lw12d
    s_sleep 1
    s_branch L_lw12
L_lw12d:
L_cf64:
    ds_read_b32 v5, v4
    s_mov_b32 m0, 87552
    s_waitcnt vmcnt(32)
    global_load_lds_dwordx4 v40, s[20:21] offset:-4096 nt
    s_mov_b32 m0, 87568
    s_waitcnt vmcnt(32)
    global_load_lds_dwordx4 v40, s[20:21] offset:-3072 nt
    s_mov_b32 m0, 87584
    s_waitcnt vmcnt(32)
    global_load_lds_dwordx4 v40, s[20:21] offset:-2048 nt
    s_mov_b32 m0, 87600
    s_waitcnt vmcnt(32)
    global_load_lds_dwordx4 v40, s[20:21] offset:-1024 nt
    s_mov_b32 m0, 87616
    s_waitcnt vmcnt(32)
    global_load_lds_dwordx4 v40, s[20:21] offset:0 nt
    s_mov_b32 m0, 87632
    s_waitcnt vmcnt(32)
    global_load_lds_dwordx4 v40, s[20:21] offset:1024 nt
    s_mov_b32 m0, 87648
    s_waitcnt vmcnt(32)
    global_load_lds_dwordx4 v40, s[20:21] offset:2048 nt
    s_mov_b32 m0, 87664
    s_waitcnt vmcnt(32)
    global_load_lds_dwordx4 v40, s[20:21] offset:3072 nt
    s_waitcnt lgkmcnt(0)
    v_readfirstlane_b32 s40, v5
    s_nop 0
    s_add_u32 s40, s40, 1
    s_lshr_b32 s40, s40, 4
    s_andn2_b32 s40, s40, s96
    s_cbranch_scc0 L_cf72
    s_mov_b32 s96, 1
    s_barrier
    v_mov_b32 v6, 380
    s_mov_b32 s39, 0
L_lw13:
    ds_read_b32 v7, v6
    s_add_u32 s39, s39, 1
    s_cmp_gt_u32 s39, 4194304
    s_cbranch_scc1 L_bail
    s_waitcnt lgkmcnt(0)
    v_readfirstlane_b32 s40, v7
    s_nop 0
    s_cmp_ge_u32 s40, 8
    s_cbranch_scc1 L_lw13d
    s_sleep 1
    s_branch L_lw13
L_lw13d:
L_cf72:
    ds_read_b32 v5, v4
    s_mov_b32 m0, 95872
    s_waitcnt vmcnt(32)
    global_load_lds_dwordx4 v41, s[20:21] offset:-4096 nt
    s_mov_b32 m0, 95888
    s_waitcnt vmcnt(32)
    global_load_lds_dwordx4 v41, s[20:21] offset:-3072 nt
    s_mov_b32 m0, 95904
    s_waitcnt vmcnt(32)
    global_load_lds_dwordx4 v41, s[20:21] offset:-2048 nt
    s_mov_b32 m0, 95920
    s_waitcnt vmcnt(32)
    global_load_lds_dwordx4 v41, s[20:21] offset:-1024 nt
    s_mov_b32 m0, 95936
    s_waitcnt vmcnt(32)
    global_load_lds_dwordx4 v41, s[20:21] offset:0 nt
    s_mov_b32 m0, 95952
    s_waitcnt vmcnt(32)
    global_load_lds_dwordx4 v41, s[20:21] offset:1024 nt
    s_mov_b32 m0, 95968
    s_waitcnt vmcnt(32)
    global_load_lds_dwordx4 v41, s[20:21] offset:2048 nt
    s_mov_b32 m0, 95984
    s_waitcnt vmcnt(32)
    global_load_lds_dwordx4 v41, s[20:21] offset:3072 nt
    s_waitcnt lgkmcnt(0)
    v_readfirstlane_b32 s40, v5
    s_nop 0
    s_add_u32 s40, s40, 1
    s_lshr_b32 s40, s40, 4
    s_andn2_b32 s40, s40, s96
    s_cbranch_scc0 L_cf80
    s_mov_b32 s96, 1
    s_barrier
    v_mov_b32 v6, 380
    s_mov_b32 s39, 0
L_lw14:
    ds_read_b32 v7, v6
    s_add_u32 s39, s39, 1
    s_cmp_gt_u32 s39, 4194304
    s_cbranch_scc1 L_bail
    s_waitcnt lgkmcnt(0)
    v_readfirstlane_b32 s40, v7
    s_nop 0
    s_cmp_ge_u32 s40, 8
    s_cbranch_scc1 L_lw14d
    s_sleep 1
    s_branch L_lw14
L_lw14d:
L_cf80:
    ds_read_b32 v5, v4
    s_mov_b32 m0, 104192
    s_waitcnt vmcnt(32)
    global_load_lds_dwordx4 v42, s[20:21] offset:-4096 nt
    s_mov_b32 m0, 104208
    s_waitcnt vmcnt(32)
    global_load_lds_dwordx4 v42, s[20:21] offset:-3072 nt
    s_mov_b32 m0, 104224
    s_waitcnt vmcnt(32)
    global_load_lds_dwordx4 v42, s[20:21] offset:-2048 nt
    s_mov_b32 m0, 104240
    s_waitcnt vmcnt(32)
    global_load_lds_dwordx4 v42, s[20:21] offset:-1024 nt
    s_mov_b32 m0, 104256
    s_waitcnt vmcnt(32)
    global_load_lds_dwordx4 v42, s[20:21] offset:0 nt
    s_mov_b32 m0, 104272
    s_waitcnt vmcnt(32)
    global_load_lds_dwordx4 v42, s[20:21] offset:1024 nt
    s_mov_b32 m0, 104288
    s_waitcnt vmcnt(32)
    global_load_lds_dwordx4 v42, s[20:21] offset:2048 nt
    s_mov_b32 m0, 104304
    s_waitcnt vmcnt(32)
    global_load_lds_dwordx4 v42, s[20:21] offset:3072 nt
    s_waitcnt lgkmcnt(0)
    v_readfirstlane_b32 s40, v5
    s_nop 0
    s_add_u32 s40, s40, 1
    s_lshr_b32 s40, s40, 4
    s_andn2_b32 s40, s40, s96
    s_cbranch_scc0 L_cf88
    s_mov_b32 s96, 1
    s_barrier
    v_mov_b32 v6, 380
    s_mov_b32 s39, 0
L_lw15:
    ds_read_b32 v7, v6
    s_add_u32 s39, s39, 1
    s_cmp_gt_u32 s39, 4194304
    s_cbranch_scc1 L_bail
    s_waitcnt lgkmcnt(0)
    v_readfirstlane_b32 s40, v7
    s_nop 0
    s_cmp_ge_u32 s40, 8
    s_cbranch_scc1 L_lw15d
    s_sleep 1
    s_branch L_lw15
L_lw15d:
L_cf88:
    ds_read_b32 v5, v4
    s_mov_b32 m0, 112512
    s_waitcnt vmcnt(32)
    global_load_lds_dwordx4 v43, s[20:21] offset:-4096 nt
    s_mov_b32 m0, 112528
    s_waitcnt vmcnt(32)
    global_load_lds_dwordx4 v43, s[20:21] offset:-3072 nt
    s_mov_b32 m0, 112544
    s_waitcnt vmcnt(32)
    global_load_lds_dwordx4 v43, s[20:21] offset:-2048 nt
    s_mov_b32 m0, 112560
    s_waitcnt vmcnt(32)
    global_load_lds_dwordx4 v43, s[20:21] offset:-1024 nt
    s_mov_b32 m0, 112576
    s_waitcnt vmcnt(32)
    global_load_lds_dwordx4 v43, s[20:21] offset:0 nt
    s_mov_b32 m0, 112592
    s_waitcnt vmcnt(32)
    global_load_lds_dwordx4 v43, s[20:21] offset:1024 nt
    s_mov_b32 m0, 112608
    s_waitcnt vmcnt(32)
    global_load_lds_dwordx4 v43, s[20:21] offset:2048 nt
    s_mov_b32 m0, 112624
    s_waitcnt vmcnt(32)
    global_load_lds_dwordx4 v43, s[20:21] offset:3072 nt
    s_cmp_lg_u32 s96, 0
    s_cbranch_scc1 L_cf3
    v_mov_b32 v6, 372
    v_mov_b32 v7, 1
    s_waitcnt vmcnt(0)
    ds_write_b32 v6, v7
    s_waitcnt lgkmcnt(0)
    s_barrier
L_cf3:
    s_waitcnt vmcnt(32)
    s_barrier
    s_waitcnt vmcnt(0)
    s_barrier
    s_endpgm
L_cmon:
    s_cmp_lg_u32 s40, 7
    s_cbranch_scc1 L_none
    s_lshl_b32 s40, s28, 9
    s_add_u32 s40, s40, 458752
    v_and_b32 v4, 31, v1
    v_lshl_add_u32 v4, v4, 4, s40
    s_lshl_b32 s40, s28, 2
    s_add_u32 s40, s40, 294912
    v_lshl_add_u32 v5, v1, 7, s40
    v_mov_b32 v6, s32
    v_mov_b32 v12, 368
    s_mov_b32 s39, 0
L_lw16:
    ds_read_b32 v13, v12
    s_add_u32 s39, s39, 1
    s_cmp_gt_u32 s39, 4194304
    s_cbranch_scc1 L_bail
    s_waitcnt lgkmcnt(0)
    v_readfirstlane_b32 s40, v13
    s_nop 0
    s_cmp_ge_u32 s40, 1
    s_cbranch_scc1 L_lw16d
    s_sleep 1
    s_branch L_lw16
L_lw16d:
    s_lshl_b32 s40, s28, 9
    s_add_u32 s40, s40, 311296
    v_lshl_add_u32 v4, v1, 3, s40
    s_mov_b32 s39, 0
L_poll17:
    global_load_dwordx2 v[8:9], v4, s[26:27] sc1
    s_add_u32 s39, s39, 1
    s_cmp_gt_u32 s39, 524288
    s_cbranch_scc1 L_bail
L_poll17w:
    s_waitcnt vmcnt(0)
L_poll17c:
    v_xor_b32 v8, s32, v8
    v_xor_b32 v9, s32, v9
    v_or_b32 v8, v8, v9
    v_cmp_ne_u32 vcc, 0, v8
    s_cbranch_vccnz L_poll17
    s_bfm_b64 exec, 43, 0
    global_store_dword v5, v6, s[26:27] sc1
    s_endpgm
L_setup:
    s_load_dword s32, s[26:27], 0
    s_sub_u32 s31, s31, 1
    v_and_b32 v80, 1, v1
    v_cmp_eq_u32 vcc, 1, v80
    v_mov_b32 v81, 0x0c0c0100
    v_mov_b32 v82, 0x01000c0c
    v_cndmask_b32 v81, v81, v82, vcc
    v_mov_b32 v82, 0x0c0c0302
    v_mov_b32 v83, 0x03020c0c
    v_cndmask_b32 v82, v82, v83, vcc
    v_bfe_u32 v80, v1, 1, 3
    v_mov_b32 v83, 0x0c0c0c0c
    v_cmp_eq_u32 vcc, 0, v80
    s_nop 1
    v_cndmask_b32 v88, v83, v81, vcc
    v_cndmask_b32 v89, v83, v82, vcc
    v_cmp_eq_u32 vcc, 1, v80
    s_nop 1
    v_cndmask_b32 v90, v83, v81, vcc
    v_cndmask_b32 v91, v83, v82, vcc
    v_cmp_eq_u32 vcc, 2, v80
    s_nop 1
    v_cndmask_b32 v92, v83, v81, vcc
    v_cndmask_b32 v93, v83, v82, vcc
    v_cmp_eq_u32 vcc, 3, v80
    s_nop 1
    v_cndmask_b32 v94, v83, v81, vcc
    v_cndmask_b32 v95, v83, v82, vcc
    v_and_b32 v3, 15, v1
    v_lshlrev_b32 v3, 4, v3
    s_mov_b32 s49, 0x3db504f3
    s_mov_b32 s50, 0x3fb8aa3b
    v_bfe_u32 v101, v1, 4, 1
    v_lshlrev_b32 v101, 6, v101
    v_lshl_add_u32 v101, v3, 3, v101
    s_lshl_b32 s40, s29, 12
    s_lshr_b32 s41, s30, 2
    s_lshl_b32 s41, s41, 11
    s_add_u32 s40, s40, s41
    s_and_b32 s41, s30, 3
    s_lshl_b32 s41, s41, 4
    s_add_u32 s40, s40, s41
    s_add_u32 s40, s40, 327680
    v_add_u32 v101, s40, v101
    s_lshl_b32 s40, s29, 7
    s_lshl_b32 s41, s30, 4
    s_add_u32 s40, s40, s41
    s_add_u32 s40, s40, 458752
    v_mov_b32 v80, s40
    v_cmp_lt_u32 s[44:45], 31, v1
    v_mov_b32 v100, 0xffffff00
    s_nop 0
    v_cndmask_b32 v101, v101, v80, s[44:45]
    v_mov_b32 v72, 0
    v_mov_b32 v73, 0
    v_mov_b32 v74, 0
    v_mov_b32 v75, 0
    v_mov_b32 v76, 0
    v_mov_b32 v77, 0
    v_mov_b32 v78, 0
    v_mov_b32 v79, 0
    s_branch L_setupr
L_stream2:
    v_mov_b32 v80, 356
    v_mov_b32 v81, 1
    s_mov_b64 exec, 1
    ds_add_u32 v80, v81
    s_mov_b64 exec, -1
    v_mov_b32 v80, 364
    s_mov_b32 s39, 0
L_lw18:
    ds_read_b32 v81, v80
    ds_read_b128 v[68:71], v3 offset:0
    s_add_u32 s39, s39, 1
    s_cmp_gt_u32 s39, 4194304
    s_cbranch_scc1 L_bail
    s_waitcnt lgkmcnt(0)
    v_readfirstlane_b32 s40, v81
    s_nop 0
    s_cmp_ge_u32 s40, 1
    s_cbranch_scc1 L_lw18d
    s_sleep 1
    s_branch L_lw18
L_lw18d:
    s_mov_b32 s54, s40
    s_add_u32 s32, s32, 2654435769
    s_lshr_b32 s33, s32, 8
    s_lshr_b32 s34, s32, 16
    s_lshr_b32 s35, s32, 24
    s_mov_b32 s36, 0x0c0c0400
    s_mov_b32 s37, 0x04000c0c
    s_waitcnt vmcnt(8) lgkmcnt(0)
    v_dot2c_f32_bf16 v72, v4, v68
    v_dot2c_f32_bf16 v73, v8, v68
    v_dot2c_f32_bf16 v74, v12, v68
    v_dot2c_f32_bf16 v75, v16, v68
    v_dot2c_f32_bf16 v76, v20, v68
    v_dot2c_f32_bf16 v77, v24, v68
    v_dot2c_f32_bf16 v78, v28, v68
    v_dot2c_f32_bf16 v79, v32, v68
    v_dot2c_f32_bf16 v72, v5, v69
    v_dot2c_f32_bf16 v73, v9, v69
    v_dot2c_f32_bf16 v74, v13, v69
    v_dot2c_f32_bf16 v75, v17, v69
    v_dot2c_f32_bf16 v76, v21, v69
    v_dot2c_f32_bf16 v77, v25, v69
    v_dot2c_f32_bf16 v78, v29, v69
    v_dot2c_f32_bf16 v79, v33, v69
    v_dot2c_f32_bf16 v72, v6, v70
    v_dot2c_f32_bf16 v73, v10, v70
    v_dot2c_f32_bf16 v74, v14, v70
    v_dot2c_f32_bf16 v75, v18, v70
    v_dot2c_f32_bf16 v76, v22, v70
    v_dot2c_f32_bf16 v77, v26, v70
    v_dot2c_f32_bf16 v78, v30, v70
    v_dot2c_f32_bf16 v79, v34, v70
    v_dot2c_f32_bf16 v72, v7, v71
    v_dot2c_f32_bf16 v73, v11, v71
    v_dot2c_f32_bf16 v74, v15, v71
    v_dot2c_f32_bf16 v75, v19, v71
    v_dot2c_f32_bf16 v76, v23, v71
    v_dot2c_f32_bf16 v77, v27, v71
    v_dot2c_f32_bf16 v78, v31, v71
    v_dot2c_f32_bf16 v79, v35, v71
    v_add_f32_dpp v72, v72, v72 row_ror:8 row_mask:0xf bank_mask:0x3
    v_add_f32_dpp v73, v73, v73 row_ror:8 row_mask:0xf bank_mask:0x3
    v_add_f32_dpp v74, v74, v74 row_ror:8 row_mask:0xf bank_mask:0x3
    v_add_f32_dpp v75, v75, v75 row_ror:8 row_mask:0xf bank_mask:0x3
    v_add_f32_dpp v72, v76, v76 row_ror:8 row_mask:0xf bank_mask:0xc
    v_add_f32_dpp v73, v77, v77 row_ror:8 row_mask:0xf bank_mask:0xc
    v_add_f32_dpp v74, v78, v78 row_ror:8 row_mask:0xf bank_mask:0xc
    v_add_f32_dpp v75, v79, v79 row_ror:8 row_mask:0xf bank_mask:0xc
    v_add_f32_dpp v72, v72, v72 row_shl:4 row_mask:0xf bank_mask:0x5
    v_add_f32_dpp v73, v73, v73 row_shl:4 row_mask:0xf bank_mask:0x5
    s_nop 0
    v_add_f32_dpp v72, v74, v74 row_shr:4 row_mask:0xf bank_mask:0xa
    v_add_f32_dpp v73, v75, v75 row_shr:4 row_mask:0xf bank_mask:0xa
    s_nop 0
    v_add_f32_dpp v72, v72, v72 quad_perm:[1,0,3,2] row_mask:0xf bank_mask:0xf
    v_add_f32_dpp v73, v73, v73 quad_perm:[1,0,3,2] row_mask:0xf bank_mask:0xf
    s_nop 0
    v_add_f32_dpp v72, v72, v72 quad_perm:[2,3,0,1] row_mask:0xf bank_mask:0xf
    v_add_f32_dpp v73, v73, v73 quad_perm:[2,3,0,1] row_mask:0xf bank_mask:0xf
    v_cvt_pk_bf16_f32 v72, 0, v72
    v_cvt_pk_bf16_f32 v73, 0, v73
    v_mul_f32 v72, s49, v72
    v_mul_f32 v73, s49, v73
    v_cvt_pk_bf16_f32 v72, 0, v72
    v_cvt_pk_bf16_f32 v73, 0, v73
    v_max_f32 v102, v72, v73
    s_nop 1
    v_max_f32_dpp v102, v102, v102 row_ror:4 row_mask:0xf bank_mask:0xf
    s_nop 1
    v_max_f32_dpp v102, v102, v102 row_ror:8 row_mask:0xf bank_mask:0xf
    v_mov_b32 v81, v102
    s_nop 1
    v_permlane16_swap_b32 v102, v81
    v_max_f32 v102, v102, v81
    v_mov_b32 v81, v102
    s_nop 1
    v_permlane32_swap_b32 v102, v81
    v_max_f32 v102, v102, v81
    v_mul_f32 v80, s50, v102
    v_fma_f32 v72, v72, s50, -v80
    v_fma_f32 v73, v73, s50, -v80
    v_exp_f32 v72, v72
    v_exp_f32 v73, v73
    s_nop 0
    v_cvt_pk_bf16_f32 v80, v72, v73
    v_add_f32 v72, v72, v73
    s_nop 0
    v_mov_b32_dpp v68, v80 row_newbcast:0 row_mask:0xf bank_mask:0xf
    v_mov_b32_dpp v69, v80 row_newbcast:4 row_mask:0xf bank_mask:0xf
    v_mov_b32_dpp v70, v80 row_newbcast:8 row_mask:0xf bank_mask:0xf
    v_mov_b32_dpp v71, v80 row_newbcast:12 row_mask:0xf bank_mask:0xf
    v_add_f32_dpp v72, v72, v72 row_ror:4 row_mask:0xf bank_mask:0xf
    s_nop 1
    v_add_f32_dpp v72, v72, v72 row_ror:8 row_mask:0xf bank_mask:0xf
    v_mov_b32 v73, v72
    s_nop 1
    v_permlane16_swap_b32 v72, v73
    v_add_f32 v72, v72, v73
    v_mov_b32 v73, v72
    s_nop 1
    v_permlane32_swap_b32 v72, v73
    v_add_f32 v72, v72, v73
    s_lshl_b32 s40, s31, 2
    v_mov_b32 v87, s40
    ds_write2_b32 v87, v102, v72 offset0:64 offset1:76
    v_mov_b32 v80, 360
    v_mov_b32 v81, 1
    s_mov_b64 exec, 1
    ds_add_u32 v80, v81
    s_mov_b64 exec, -1
    v_perm_b32 v4, v68, v68, v88
    v_perm_b32 v5, v68, v68, v90
    v_perm_b32 v6, v68, v68, v92
    v_perm_b32 v7, v68, v68, v94
    v_perm_b32 v8, v68, v68, v89
    v_perm_b32 v9, v68, v68, v91
    v_perm_b32 v10, v68, v68, v93
    v_perm_b32 v11, v68, v68, v95
    v_perm_b32 v12, v69, v69, v88
    v_perm_b32 v13, v69, v69, v90
    v_perm_b32 v14, v69, v69, v92
    v_perm_b32 v15, v69, v69, v94
    v_perm_b32 v16, v69, v69, v89
    v_perm_b32 v17, v69, v69, v91
    v_perm_b32 v18, v69, v69, v93
    v_perm_b32 v19, v69, v69, v95
    v_perm_b32 v20, v70, v70, v88
    v_perm_b32 v21, v70, v70, v90
    v_perm_b32 v22, v70, v70, v92
    v_perm_b32 v23, v70, v70, v94
    v_perm_b32 v24, v70, v70, v89
    v_perm_b32 v25, v70, v70, v91
    v_perm_b32 v26, v70, v70, v93
    v_perm_b32 v27, v70, v70, v95
    v_perm_b32 v28, v71, v71, v88
    v_perm_b32 v29, v71, v71, v90
    v_perm_b32 v30, v71, v71, v92
    v_perm_b32 v31, v71, v71, v94
    v_perm_b32 v32, v71, v71, v89
    v_perm_b32 v33, v71, v71, v91
    v_perm_b32 v34, v71, v71, v93
    v_perm_b32 v35, v71, v71, v95
    v_and_b32 v82, 15, v1
    v_cmp_gt_u32 vcc, 12, v82
    v_min_u32 v82, 11, v82
    v_lshlrev_b32 v82, 2, v82
    s_lshl_b32 s41, s31, 9
    v_lshl_add_u32 v3, v1, 4, s41
    v_and_b32 v83, 31, v1
    v_lshlrev_b32 v83, 4, v83
    v_lshrrev_b32 v84, 5, v1
    v_mul_u32_u24 v84, 2048, v84
    v_add_u32 v83, v84, v83
    s_sub_u32 s42, s55, 1
    v_mov_b32 v80, 360
    s_mov_b32 s39, 0
L_lw19:
    ds_read_b32 v81, v80
    ds_read2_b32 v[74:75], v82 offset0:64 offset1:76
    s_add_u32 s39, s39, 1
    s_cmp_gt_u32 s39, 4194304
    s_cbranch_scc1 L_bail
    s_waitcnt lgkmcnt(0)
    v_readfirstlane_b32 s40, v81
    s_nop 0
    s_cmp_ge_u32 s40, s55
    s_cbranch_scc1 L_lw19d
    s_sleep 1
    s_branch L_lw19
L_lw19d:
    v_mov_b32 v80, 352
    v_mov_b32 v81, 1
    s_waitcnt lgkmcnt(0)
    v_cndmask_b32 v75, 0, v75, vcc
    v_mov_b32 v68, v74
    s_nop 1
    v_max_f32_dpp v68, v68, v68 row_ror:1 row_mask:0xf bank_mask:0xf
    s_nop 1
    v_max_f32_dpp v68, v68, v68 row_ror:2 row_mask:0xf bank_mask:0xf
    s_nop 1
    v_max_f32_dpp v68, v68, v68 row_ror:4 row_mask:0xf bank_mask:0xf
    s_nop 1
    v_max_f32_dpp v68, v68, v68 row_ror:8 row_mask:0xf bank_mask:0xf
    v_sub_f32 v104, v102, v68
    v_sub_f32 v74, v74, v68
    v_mul_f32 v104, s50, v104
    v_mul_f32 v74, s50, v74
    v_exp_f32 v104, v104
    v_exp_f32 v74, v74
    v_mov_b32 v102, v68
    v_mul_f32 v103, v74, v75
    v_mov_b32 v105, v104
    s_nop 0
    v_add_f32_dpp v103, v103, v103 row_ror:1 row_mask:0xf bank_mask:0xf
    s_nop 1
    v_add_f32_dpp v103, v103, v103 row_ror:2 row_mask:0xf bank_mask:0xf
    s_nop 1
    v_add_f32_dpp v103, v103, v103 row_ror:4 row_mask:0xf bank_mask:0xf
    s_nop 1
    v_add_f32_dpp v103, v103, v103 row_ror:8 row_mask:0xf bank_mask:0xf
    s_setprio 2
    s_waitcnt vmcnt(7)
    v_mfma_f32_16x16x32_bf16 v[96:99], v[4:7], v[36:39], 0
    s_waitcnt vmcnt(6)
    v_mfma_f32_16x16x32_bf16 v[96:99], v[8:11], v[40:43], v[96:99]
    s_waitcnt vmcnt(5)
    v_mfma_f32_16x16x32_bf16 v[96:99], v[12:15], v[44:47], v[96:99]
    s_waitcnt vmcnt(4)
    v_mfma_f32_16x16x32_bf16 v[96:99], v[16:19], v[48:51], v[96:99]
    s_waitcnt vmcnt(3)
    v_mfma_f32_16x16x32_bf16 v[96:99], v[20:23], v[52:55], v[96:99]
    s_waitcnt vmcnt(2)
    v_mfma_f32_16x16x32_bf16 v[96:99], v[24:27], v[56:59], v[96:99]
    s_waitcnt vmcnt(1)
    v_mfma_f32_16x16x32_bf16 v[96:99], v[28:31], v[60:63], v[96:99]
    s_waitcnt vmcnt(0)
    v_mfma_f32_16x16x32_bf16 v[96:99], v[32:35], v[64:67], v[96:99]
    s_mov_b32 exec_hi, 0
    s_nop 6
    v_pk_mul_f32 v[96:97], v[96:97], v[104:105]
    v_pk_mul_f32 v[98:99], v[98:99], v[104:105]
    ds_write_b128 v3, v[96:99] offset:512
    s_mov_b32 exec_lo, 1
    ds_add_rtn_u32 v85, v80, v81
    s_mov_b64 exec, -1
    ds_read_b128 v[4:7], v83 offset:512
    ds_read_b128 v[8:11], v83 offset:1024
    ds_read_b128 v[12:15], v83 offset:1536
    ds_read_b128 v[16:19], v83 offset:2048
    ds_read_b32 v86, v80 offset:32
    s_waitcnt lgkmcnt(0)
    v_readlane_b32 s40, v85, 0
    v_readfirstlane_b32 s54, v86
    s_cmp_lg_u32 s40, s42
    s_cbranch_scc1 L_role
    v_pk_add_f32 v[4:5], v[4:5], v[8:9]
    v_pk_add_f32 v[12:13], v[12:13], v[16:17]
    v_pk_add_f32 v[6:7], v[6:7], v[10:11]
    v_pk_add_f32 v[14:15], v[14:15], v[18:19]
    v_pk_add_f32 v[4:5], v[4:5], v[12:13]
    v_pk_add_f32 v[6:7], v[6:7], v[14:15]
    s_nop 0
    v_permlane32_swap_b32 v4, v8
    v_permlane32_swap_b32 v5, v9
    v_permlane32_swap_b32 v6, v10
    v_permlane32_swap_b32 v7, v11
    v_pk_add_f32 v[4:5], v[4:5], v[8:9]
    v_pk_add_f32 v[6:7], v[6:7], v[10:11]
    v_cndmask_b32 v4, v4, v102, s[44:45]
    v_cndmask_b32 v5, v5, v103, s[44:45]
    s_cmp_eq_u32 s54, 3
    v_bfi_b32 v4, v100, v4, s32
    v_bfi_b32 v5, v100, v5, s33
    v_bfi_b32 v6, v100, v6, s34
    v_bfi_b32 v7, v100, v7, s35
    s_mov_b32 exec_hi, 1
    s_cbranch_scc1 L_publoc
    global_store_dwordx4 v101, v[4:7], s[26:27] sc1
    s_branch L_pubdone
L_publoc:
    global_store_dwordx4 v101, v[4:7], s[26:27]
L_pubdone:
    s_mov_b32 exec_hi, -1
    ds_write_b32 v80, v81 offset:16
L_role:
    s_setprio 0
    s_cmp_gt_u32 s31, 8
    s_cbranch_scc1 L_none
    s_and_b32 s40, s29, 3
    s_lshl_b32 s48, s40, 2
    s_lshr_b32 s40, s30, 2
    s_lshl_b32 s40, s40, 1
    s_add_u32 s48, s48, s40
    s_and_b32 s40, s30, 1
    s_add_u32 s48, s48, s40
    s_bitcmp0_b32 s30, 1
    s_cbranch_scc1 L_wo
    s_cmp_lt_u32 s48, 8
    s_cbranch_scc1 L_none
    s_sub_u32 s40, s48, 8
    s_min_u32 s41, s28, 3
    s_mul_i32 s48, s28, 5
    s_add_u32 s48, s48, s41
    s_add_u32 s48, s48, s40
    s_cmp_lt_u32 s28, 3
    s_cselect_b32 s41, 6, 5
    s_cmp_lt_u32 s40, s41
    s_cbranch_scc1 L_ffn
    s_branch L_none
L_idle1:
    s_mov_b32 s50, 0x3fb8aa3b
    v_mov_b32 v100, 0xffffff00
    s_add_u32 s32, s32, 2654435769
    s_lshr_b32 s33, s32, 8
    s_lshr_b32 s34, s32, 16
    s_lshr_b32 s35, s32, 24
    s_mov_b32 s36, 0x0c0c0400
    s_mov_b32 s37, 0x04000c0c
    s_sub_u32 s31, s31, 1
    s_cmp_lg_u32 s31, 8
    s_cbranch_scc1 L_xt2
    v_mov_b32 v80, 364
    s_mov_b32 s39, 0
L_lw20:
    ds_read_b32 v81, v80
    s_add_u32 s39, s39, 1
    s_cmp_gt_u32 s39, 4194304
    s_cbranch_scc1 L_bail
    s_waitcnt lgkmcnt(0)
    v_readfirstlane_b32 s40, v81
    s_nop 0
    s_cmp_ge_u32 s40, 1
    s_cbranch_scc1 L_lw20d
    s_sleep 1
    s_branch L_lw20
L_lw20d:
    s_cmp_eq_u32 s40, 3
    s_cbranch_scc1 L_xt2
    s_getreg_b32 s42, hwreg(HW_REG_XCC_ID, 0, 4)
    s_and_b32 s40, s32, 0xffffff00
    s_or_b32 s42, s42, s40
    s_lshl_b32 s40, s28, 7
    s_add_u32 s40, s40, 1024
    v_and_b32 v2, 31, v1
    v_lshl_add_u32 v2, v2, 2, s40
    v_mov_b32 v80, 368
    s_mov_b32 s39, 0
L_xt0:
    global_load_dword v3, v2, s[26:27] sc1
    s_add_u32 s39, s39, 1
    s_cmp_gt_u32 s39, 524288
    s_cbranch_scc1 L_bail
    s_waitcnt vmcnt(0)
    v_cmp_ne_u32 vcc, s42, v3
    s_cbranch_vccz L_xt1
    ds_read_b32 v81, v80
    s_waitcnt lgkmcnt(0)
    v_readfirstlane_b32 s40, v81
    s_nop 0
    s_cmp_lg_u32 s40, 0
    s_cbranch_scc1 L_xt2
    s_branch L_xt0
L_xt1:
    v_mov_b32 v81, 3
    ds_write_b32 v80, v81 offset:16
L_xt2:
    v_mov_b32 v80, 368
    s_mov_b32 s39, 0
L_lw21:
    ds_read_b32 v81, v80
    s_add_u32 s39, s39, 1
    s_cmp_gt_u32 s39, 4194304
    s_cbranch_scc1 L_bail
    s_waitcnt lgkmcnt(0)
    v_readfirstlane_b32 s40, v81
    s_nop 0
    s_cmp_ge_u32 s40, 1
    s_cbranch_scc1 L_lw21d
    s_sleep 1
    s_branch L_lw21
L_lw21d:
    s_branch L_role
L_wo:
    s_cmp_eq_u32 s31, 8
    s_cbranch_scc1 L_none
    v_lshrrev_b32 v2, 4, v1
    v_bfe_u32 v52, v1, 3, 1
    v_and_b32 v53, 3, v1
    v_bfe_u32 v54, v1, 4, 1
    v_lshrrev_b32 v55, 5, v1
    s_lshl_b32 s40, s31, 2
    v_add_u32 v3, s40, v54
    v_mul_u32_u24 v3, 1056, v3
    v_lshl_add_u32 v3, v55, 9, v3
    v_bfe_u32 v56, v1, 2, 2
    v_lshl_add_u32 v3, v56, 6, v3
    v_lshl_add_u32 v3, v53, 3, v3
    s_lshl_b32 s40, s28, 2
    s_lshr_b32 s41, s31, 1
    s_add_u32 s40, s40, s41
    s_lshl_b32 s41, s40, 7
    s_add_u32 s41, s41, 458752
    v_lshl_add_u32 v61, v52, 2, v53
    v_lshl_add_u32 v61, v61, 4, s41
    s_lshl_b32 s40, s40, 12
    s_and_b32 s41, s31, 1
    s_lshl_b32 s41, s41, 10
    s_add_u32 s40, s40, s41
    s_add_u32 s40, s40, 327680
    v_bfe_u32 v60, v1, 2, 1
    v_lshl_add_u32 v60, v60, 1, v54
    v_lshl_add_u32 v60, v60, 1, v55
    v_lshlrev_b32 v60, 7, v60
    v_lshl_add_u32 v60, v52, 11, v60
    v_lshl_add_u32 v60, v53, 4, v60
    v_add_u32 v60, s40, v60
    v_and_b32 v63, 15, v1
    v_lshlrev_b32 v62, 2, v63
    v_lshl_add_u32 v62, v55, 7, v62
    v_lshl_add_u32 v62, v54, 8, v62
    s_lshl_b32 s40, s31, 9
    s_add_u32 s40, s40, 6656
    v_add_u32 v62, s40, v62
    v_lshlrev_b32 v63, 4, v63
    v_lshl_add_u32 v63, v2, 10, v63
    s_lshl_b32 s40, s28, 11
    s_lshl_b32 s41, s48, 7
    s_add_u32 s40, s40, s41
    s_add_u32 s40, s40, 524288
    v_and_b32 v64, 7, v1
    v_lshl_add_u32 v64, v64, 4, s40
    v_lshl_add_u32 v64, v52, 14, v64
    v_cmp_eq_u32 s[46:47], 1, v54
    v_mov_b32 v65, 388
    v_mov_b32 v66, 1
    s_lshl_b32 s40, s28, 9
    s_lshl_b32 s41, s48, 5
    s_add_u32 s40, s40, s41
    s_lshl_b32 s41, s31, 2
    s_add_u32 s40, s40, s41
    s_add_u32 s40, s40, 311296
    v_mov_b32 v67, s40
    v_mov_b32 v68, s32
    s_mov_b32 s39, 0
L_poll22:
    global_load_dwordx4 v[44:47], v61, s[26:27] sc1
    s_add_u32 s39, s39, 1
    s_cmp_gt_u32 s39, 524288
    s_cbranch_scc1 L_bail
L_poll22w:
    s_waitcnt vmcnt(0)
L_poll22c:
    v_perm_b32 v52, v45, v44, s36
    v_perm_b32 v53, v47, v46, s37
    v_bitop3_b32 v52, v52, v53, s32 bitop3:0x56
    v_cmp_ne_u32 vcc, 0, v52
    s_cbranch_vccnz L_poll22
    s_setprio 2
    s_mov_b32 s39, 0
    global_load_dwordx4 v[36:39], v60, s[26:27] sc1
    global_load_dwordx4 v[40:43], v60, s[26:27] offset:64 sc1
    v_and_b32 v44, v100, v44
    v_and_b32 v45, v100, v45
    s_nop 0
    v_max_f32_dpp v46, v44, v44 quad_perm:[1,0,3,2] row_mask:0xf bank_mask:0xf
    s_nop 1
    v_max_f32_dpp v46, v46, v46 quad_perm:[2,3,0,1] row_mask:0xf bank_mask:0xf
    v_sub_f32 v44, v44, v46
    v_mul_f32 v44, s50, v44
    v_exp_f32 v44, v44
    s_nop 0
    v_mul_f32 v45, v45, v44
    s_nop 1
    v_add_f32_dpp v45, v45, v45 quad_perm:[1,0,3,2] row_mask:0xf bank_mask:0xf
    s_nop 1
    v_add_f32_dpp v45, v45, v45 quad_perm:[2,3,0,1] row_mask:0xf bank_mask:0xf
    v_rcp_f32 v45, v45
    s_nop 0
    v_mul_f32 v44, v44, v45
    v_mov_b32 v58, 372
    s_mov_b32 s39, 0
L_lw24:
    ds_read_b32 v59, v58
    ds_read_b64_tr_b16 v[4:5], v3 offset:15616
    ds_read_b64_tr_b16 v[6:7], v3 offset:15872
    ds_read_b64_tr_b16 v[8:9], v3 offset:15648
    ds_read_b64_tr_b16 v[10:11], v3 offset:15904
    ds_read_b64_tr_b16 v[12:13], v3 offset:17728
    ds_read_b64_tr_b16 v[14:15], v3 offset:17984
    ds_read_b64_tr_b16 v[16:17], v3 offset:17760
    ds_read_b64_tr_b16 v[18:19], v3 offset:18016
    s_add_u32 s39, s39, 1
    s_cmp_gt_u32 s39, 4194304
    s_cbranch_scc1 L_bail
    s_waitcnt lgkmcnt(0)
    v_readfirstlane_b32 s40, v59
    s_nop 0
    s_cmp_ge_u32 s40, 1
    s_cbranch_scc0 L_lw24
    s_mov_b32 s39, 0
    s_cmp_eq_u32 s54, 3
    s_cbranch_scc1 L_wrd
    global_store_dword v67, v68, s[26:27] sc1
    s_branch L_wqd
L_wrd:
    global_store_dword v67, v68, s[26:27]
L_wqd:
    s_waitcnt vmcnt(1)
    s_branch L_poll23c
L_poll23:
    global_load_dwordx4 v[36:39], v60, s[26:27] sc1
    global_load_dwordx4 v[40:43], v60, s[26:27] offset:64 sc1
    s_add_u32 s39, s39, 1
    s_cmp_gt_u32 s39, 524288
    s_cbranch_scc1 L_bail
L_poll23w:
    s_waitcnt vmcnt(0)
L_poll23c:
    v_perm_b32 v52, v37, v36, s36
    v_perm_b32 v53, v39, v38, s37
    v_perm_b32 v54, v41, v40, s36
    v_perm_b32 v55, v43, v42, s37
    v_bitop3_b32 v52, v52, v53, s32 bitop3:0x56
    v_bitop3_b32 v54, v54, v55, s32 bitop3:0x56
    v_or_b32 v52, v52, v54
    v_cmp_ne_u32 vcc, 0, v52
    s_cbranch_vccnz L_poll23
    v_and_b32 v36, v100, v36
    v_and_b32 v37, v100, v37
    v_and_b32 v38, v100, v38
    v_and_b32 v39, v100, v39
    v_and_b32 v40, v100, v40
    v_and_b32 v41, v100, v41
    v_and_b32 v42, v100, v42
    v_and_b32 v43, v100, v43
    v_pk_mul_f32 v[36:37], v[36:37], v[44:45] op_sel_hi:[1,0]
    v_pk_mul_f32 v[38:39], v[38:39], v[44:45] op_sel_hi:[1,0]
    v_pk_mul_f32 v[40:41], v[40:41], v[44:45] op_sel_hi:[1,0]
    v_pk_mul_f32 v[42:43], v[42:43], v[44:45] op_sel_hi:[1,0]
    v_add_f32_dpp v36, v36, v36 quad_perm:[1,0,3,2] row_mask:0xf bank_mask:0xf
    v_add_f32_dpp v37, v37, v37 quad_perm:[1,0,3,2] row_mask:0xf bank_mask:0xf
    v_add_f32_dpp v38, v38, v38 quad_perm:[1,0,3,2] row_mask:0xf bank_mask:0xf
    v_add_f32_dpp v39, v39, v39 quad_perm:[1,0,3,2] row_mask:0xf bank_mask:0xf
    v_add_f32_dpp v40, v40, v40 quad_perm:[1,0,3,2] row_mask:0xf bank_mask:0xf
    v_add_f32_dpp v41, v41, v41 quad_perm:[1,0,3,2] row_mask:0xf bank_mask:0xf
    v_add_f32_dpp v42, v42, v42 quad_perm:[1,0,3,2] row_mask:0xf bank_mask:0xf
    v_add_f32_dpp v43, v43, v43 quad_perm:[1,0,3,2] row_mask:0xf bank_mask:0xf
    v_add_f32_dpp v36, v36, v36 quad_perm:[2,3,0,1] row_mask:0xf bank_mask:0xf
    v_add_f32_dpp v37, v37, v37 quad_perm:[2,3,0,1] row_mask:0xf bank_mask:0xf
    v_add_f32_dpp v38, v38, v38 quad_perm:[2,3,0,1] row_mask:0xf bank_mask:0xf
    v_add_f32_dpp v39, v39, v39 quad_perm:[2,3,0,1] row_mask:0xf bank_mask:0xf
    v_add_f32_dpp v40, v40, v40 quad_perm:[2,3,0,1] row_mask:0xf bank_mask:0xf
    v_add_f32_dpp v41, v41, v41 quad_perm:[2,3,0,1] row_mask:0xf bank_mask:0xf
    v_add_f32_dpp v42, v42, v42 quad_perm:[2,3,0,1] row_mask:0xf bank_mask:0xf
    v_add_f32_dpp v43, v43, v43 quad_perm:[2,3,0,1] row_mask:0xf bank_mask:0xf
    v_cvt_pk_bf16_f32 v48, v36, v37
    v_cvt_pk_bf16_f32 v49, v38, v39
    v_cvt_pk_bf16_f32 v50, v40, v41
    v_cvt_pk_bf16_f32 v51, v42, v43
    s_waitcnt lgkmcnt(0)
    s_nop 0
    v_mfma_f32_16x16x32_bf16 v[20:23], v[48:51], v[4:7], 0
    v_mfma_f32_16x16x32_bf16 v[24:27], v[48:51], v[12:15], 0
    v_mfma_f32_16x16x32_bf16 v[28:31], v[48:51], v[8:11], 0
    v_mfma_f32_16x16x32_bf16 v[32:35], v[48:51], v[16:19], 0
    s_nop 5
    v_cndmask_b32 v36, v20, v24, s[46:47]
    s_nop 0
    v_cndmask_b32 v37, v28, v32, s[46:47]
    ds_write2_b32 v62, v36, v37 offset0:0 offset1:16
    s_mov_b64 exec, 1
    ds_add_rtn_u32 v38, v65, v66
    s_mov_b64 exec, -1
    ds_read_b128 v[4:7], v63 offset:6656
    ds_read_b128 v[8:11], v63 offset:6912
    ds_read_b128 v[12:15], v63 offset:7168
    ds_read_b128 v[16:19], v63 offset:7424
    s_waitcnt lgkmcnt(0)
    v_readlane_b32 s40, v38, 0
    s_nop 0
    s_cmp_lg_u32 s40, 7
    s_cbranch_scc1 L_none
    v_pk_add_f32 v[4:5], v[4:5], v[8:9]
    v_pk_add_f32 v[12:13], v[12:13], v[16:17]
    v_pk_add_f32 v[6:7], v[6:7], v[10:11]
    v_pk_add_f32 v[14:15], v[14:15], v[18:19]
    v_pk_add_f32 v[4:5], v[4:5], v[12:13]
    v_pk_add_f32 v[6:7], v[6:7], v[14:15]
    s_nop 0
    v_permlane32_swap_b32 v4, v8
    v_permlane32_swap_b32 v5, v9
    v_permlane32_swap_b32 v6, v10
    v_permlane32_swap_b32 v7, v11
    v_pk_add_f32 v[4:5], v[4:5], v[8:9]
    v_pk_add_f32 v[6:7], v[6:7], v[10:11]
    s_nop 0
    v_permlane16_swap_b32 v4, v8
    v_permlane16_swap_b32 v5, v9
    v_permlane16_swap_b32 v6, v10
    v_permlane16_swap_b32 v7, v11
    v_pk_add_f32 v[4:5], v[4:5], v[8:9]
    v_pk_add_f32 v[6:7], v[6:7], v[10:11]
    v_bfi_b32 v4, v100, v4, s32
    v_bfi_b32 v5, v100, v5, s33
    v_bfi_b32 v6, v100, v6, s34
    v_bfi_b32 v7, v100, v7, s35
    s_mov_b64 exec, 0xffff
    global_store_dwordx4 v64, v[4:7], s[26:27] sc1
    s_endpgm
L_ffn:
    s_cmp_lg_u32 s31, 8
    s_cbranch_scc1 L_ffn1
    v_mov_b32 v2, 376
    s_mov_b32 s42, 0
    s_lshr_b32 s40, s48, 0
    s_lshl_b32 s40, s40, 7
    s_add_u32 s40, s40, 294912
    s_add_u32 s52, s26, s40
    s_addc_u32 s53, s27, 0
    s_mov_b32 s98, s32
    s_mov_b32 s99, s32
    s_mov_b32 s39, 0
L_sp25:
    s_load_dwordx8 s[56:63], s[52:53], 0 glc
    s_add_u32 s39, s39, 1
    s_cmp_gt_u32 s39, 524288
    s_cbranch_scc1 L_bail
    s_waitcnt lgkmcnt(0)
    s_mov_b32 s40, 0
    s_cmp_eq_u64 s[56:57], s[98:99]
    s_cselect_b32 s41, 1, 0
    s_or_b32 s40, s40, s41
    s_cmp_eq_u64 s[58:59], s[98:99]
    s_cselect_b32 s41, 2, 0
    s_or_b32 s40, s40, s41
    s_cmp_eq_u64 s[60:61], s[98:99]
    s_cselect_b32 s41, 4, 0
    s_or_b32 s40, s40, s41
    s_cmp_eq_u64 s[62:63], s[98:99]
    s_cselect_b32 s41, 8, 0
    s_or_b32 s40, s40, s41
    s_cmp_eq_u32 s40, s42
    s_cbranch_scc1 L_fh0
    v_mov_b32 v3, s40
    s_mov_b32 s42, s40
    ds_write_b32 v2, v3
L_fh0:
    s_cmp_lg_u32 s40, 15
    s_cbranch_scc1 L_sp25
    s_barrier
    s_endpgm
L_ffn1:
    v_mov_b32 v128, 0xffffff00
    v_lshrrev_b32 v84, 4, v1
    v_bfe_u32 v85, v1, 3, 1
    v_and_b32 v86, 3, v1
    v_bfe_u32 v87, v1, 2, 2
    v_lshrrev_b32 v88, 5, v1
    v_bfe_u32 v89, v1, 4, 1
    s_lshl_b32 s40, s31, 4
    v_and_b32 v3, 15, v1
    v_add_u32 v3, s40, v3
    v_lshlrev_b32 v136, 3, v3
    v_lshl_add_u32 v136, v89, 2, v136
    v_lshl_add_u32 v135, v88, 10, v136
    global_load_dword v132, v135, s[4:5]
    v_mul_u32_u24 v2, 1088, v88
    v_add_u32 v136, v2, v136
    v_lshlrev_b32 v130, 4, v3
    v_lshl_add_u32 v130, v88, 14, v130
    v_lshl_add_u32 v130, v89, 11, v130
    v_bfe_u32 v3, v1, 2, 1
    v_add_u32 v131, 536576, v130
    v_add_u32 v130, 528384, v130
    s_lshl_b32 s40, s31, 3
    v_lshlrev_b32 v137, 6, v88
    v_add_u32 v138, s40, v137
    v_and_b32 v139, 1, v1
    v_mul_u32_u24 v139, 1088, v139
    v_lshl_add_u32 v139, v89, 5, v139
    v_lshl_add_u32 v139, v88, 4, v139
    v_and_b32 v2, 2, v1
    v_cmp_ne_u32 vcc, 0, v2
    v_lshlrev_b32 v2, 5, v89
    v_lshl_add_u32 v2, v88, 4, v2
    v_add_u32 v139, 13312, v139
    v_add_u32 v2, 11392, v2
    v_cndmask_b32 v139, v139, v2, vcc
    v_lshlrev_b32 v137, 6, v89
    v_lshlrev_b32 v141, 6, v3
    v_lshl_add_u32 v141, v84, 4, v141
    v_and_b32 v140, 7, v1
    v_lshlrev_b32 v140, 1, v140
    v_lshl_add_u32 v140, v89, 6, v140
    s_lshl_b32 s40, s31, 4
    v_add_u32 v140, s40, v140
    s_lshl_b32 s41, s31, 1
    v_add_u32 v134, s41, v88
    v_lshl_add_u32 v134, v134, 1, v3
    v_mul_u32_u24 v134, 6144, v134
    s_lshl_b32 s41, s48, 7
    s_add_u32 s41, s41, 1114112
    v_lshl_add_u32 v134, v86, 4, v134
    v_lshl_add_u32 v134, v89, 6, v134
    v_add_u32 v134, s41, v134
    v_bfe_u32 v2, v1, 1, 1
    v_mul_u32_u24 v2, 33808, v2
    v_mul_u32_u24 v3, 1056, v89
    v_add_u32 v2, v2, v3
    v_lshl_add_u32 v2, v88, 9, v2
    v_lshl_add_u32 v2, v87, 6, v2
    v_and_b32 v3, 1, v1
    v_lshl_add_u32 v2, v3, 3, v2
    s_and_b32 s40, s31, 3
    s_lshl_b32 s40, s40, 4
    v_add_u32 v2, s40, v2
    v_lshl_add_u32 v3, v84, 3, v87
    v_mul_u32_u24 v3, 1040, v3
    v_lshl_add_u32 v3, v86, 5, v3
    s_lshl_b32 s41, s31, 7
    s_add_u32 s41, s41, 83456
    v_add_u32 v3, s41, v3
    s_mul_i32 s41, s48, 6144
    s_lshl_b32 s42, s31, 6
    s_add_u32 s41, s41, s42
    s_add_u32 s41, s41, 1114112
    v_lshrrev_b32 v142, 2, v1
    v_lshlrev_b32 v142, 7, v142
    v_lshl_add_u32 v142, v86, 4, v142
    v_add_u32 v142, s41, v142
    v_cmp_gt_u32 vcc, 44, v1
    v_add_u32 v143, 4096, v142
    s_nop 0
    v_cndmask_b32 v143, v142, v143, vcc
    v_cndmask_b32 v144, 0, v128, vcc
    s_and_b32 s41, s48, 1
    s_lshl_b32 s41, s41, 9
    s_lshr_b32 s42, s48, 1
    s_lshl_b32 s42, s42, 5
    s_add_u32 s41, s41, s42
    s_lshl_b32 s42, s31, 4
    s_add_u32 s41, s41, s42
    v_lshl_add_u32 v145, v89, 1, v88
    v_lshl_add_u32 v145, v86, 2, v145
    v_add_u32 v145, s41, v145
    v_lshlrev_b32 v145, 1, v145
    s_and_b32 s41, s48, 1
    s_mul_i32 s41, s41, 64
    v_add_u32 v135, s41, v145
    v_cmp_eq_u32 s[46:47], 1, v89
    s_mov_b32 s49, 0x3d372713
    s_mov_b32 s51, 0xc0135761
    v_mov_b32 v100, 372
    s_mov_b32 s96, 0
    s_mov_b32 s39, 0
    s_waitcnt vmcnt(0)
    v_lshlrev_b32 v126, 16, v132
    v_and_b32 v127, s38, v132
    s_mov_b32 s42, 0
L_fw:
    ds_read2_b32 v[102:103], v100 offset0:0 offset1:1
    s_add_u32 s39, s39, 1
    s_cmp_gt_u32 s39, 4194304
    s_cbranch_scc1 L_bail
    s_waitcnt lgkmcnt(0)
    v_readfirstlane_b32 s41, v103
    v_readfirstlane_b32 s40, v102
    s_andn2_b32 s43, s41, s42
    s_cbranch_scc0 L_fw1
    s_bitcmp0_b32 s43, 0
    s_cbranch_scc1 L_fl0
    global_load_dwordx4 v[84:87], v130, s[26:27] offset:-4096 sc1
L_fl0:
    s_bitcmp0_b32 s43, 1
    s_cbranch_scc1 L_fl1
    global_load_dwordx4 v[88:91], v130, s[26:27] offset:0 sc1
L_fl1:
    s_bitcmp0_b32 s43, 2
    s_cbranch_scc1 L_fl2
    global_load_dwordx4 v[92:95], v131, s[26:27] offset:-4096 sc1
L_fl2:
    s_bitcmp0_b32 s43, 3
    s_cbranch_scc1 L_fl3
    global_load_dwordx4 v[96:99], v131, s[26:27] offset:0 sc1
L_fl3:
    s_mov_b32 s42, s41
    s_bcnt1_i32_b32 s43, s41
    s_cmp_ge_u32 s43, 2
    s_cbranch_scc1 L_fgo
L_fw1:
    s_andn2_b32 s40, s40, s96
    s_cbranch_scc0 L_fw0
    s_mov_b32 s96, 1
    ds_read_b64_tr_b16 v[68:69], v3 offset:0
    ds_read_b64_tr_b16 v[70:71], v3 offset:4160
    ds_read_b64_tr_b16 v[72:73], v3 offset:8
    ds_read_b64_tr_b16 v[74:75], v3 offset:4168
    ds_read_b64_tr_b16 v[76:77], v3 offset:16
    ds_read_b64_tr_b16 v[78:79], v3 offset:4176
    ds_read_b64_tr_b16 v[80:81], v3 offset:24
    ds_read_b64_tr_b16 v[82:83], v3 offset:4184
    s_cmp_gt_u32 s31, 3
    s_cbranch_scc1 L_ffra
    ds_read_b64_tr_b16 v[4:5], v2 offset:15616
    ds_read_b64_tr_b16 v[6:7], v2 offset:15872
    ds_read_b64_tr_b16 v[8:9], v2 offset:17728
    ds_read_b64_tr_b16 v[10:11], v2 offset:17984
    ds_read_b64_tr_b16 v[12:13], v2 offset:19840
    ds_read_b64_tr_b16 v[14:15], v2 offset:20096
    ds_read_b64_tr_b16 v[16:17], v2 offset:21952
    ds_read_b64_tr_b16 v[18:19], v2 offset:22208
    ds_read_b64_tr_b16 v[20:21], v2 offset:24064
    ds_read_b64_tr_b16 v[22:23], v2 offset:24320
    ds_read_b64_tr_b16 v[24:25], v2 offset:26176
    ds_read_b64_tr_b16 v[26:27], v2 offset:26432
    ds_read_b64_tr_b16 v[28:29], v2 offset:28288
    ds_read_b64_tr_b16 v[30:31], v2 offset:28544
    ds_read_b64_tr_b16 v[32:33], v2 offset:30400
    ds_read_b64_tr_b16 v[34:35], v2 offset:30656
    ds_read_b64_tr_b16 v[36:37], v2 offset:32512
    ds_read_b64_tr_b16 v[38:39], v2 offset:32768
    ds_read_b64_tr_b16 v[40:41], v2 offset:34624
    ds_read_b64_tr_b16 v[42:43], v2 offset:34880
    ds_read_b64_tr_b16 v[44:45], v2 offset:36736
    ds_read_b64_tr_b16 v[46:47], v2 offset:36992
    ds_read_b64_tr_b16 v[48:49], v2 offset:38848
    ds_read_b64_tr_b16 v[50:51], v2 offset:39104
    ds_read_b64_tr_b16 v[52:53], v2 offset:40960
    ds_read_b64_tr_b16 v[54:55], v2 offset:41216
    ds_read_b64_tr_b16 v[56:57], v2 offset:43072
    ds_read_b64_tr_b16 v[58:59], v2 offset:43328
    ds_read_b64_tr_b16 v[60:61], v2 offset:45184
    ds_read_b64_tr_b16 v[62:63], v2 offset:45440
    ds_read_b64_tr_b16 v[64:65], v2 offset:47296
    ds_read_b64_tr_b16 v[66:67], v2 offset:47552
L_ffra:
L_fw0:
    s_branch L_fw
L_fgo:
    s_andn2_b32 s40, s40, s96
    s_cbranch_scc0 L_fx
    s_mov_b32 s96, 1
    ds_read_b64_tr_b16 v[68:69], v3 offset:0
    ds_read_b64_tr_b16 v[70:71], v3 offset:4160
    ds_read_b64_tr_b16 v[72:73], v3 offset:8
    ds_read_b64_tr_b16 v[74:75], v3 offset:4168
    ds_read_b64_tr_b16 v[76:77], v3 offset:16
    ds_read_b64_tr_b16 v[78:79], v3 offset:4176
    ds_read_b64_tr_b16 v[80:81], v3 offset:24
    ds_read_b64_tr_b16 v[82:83], v3 offset:4184
    s_cmp_gt_u32 s31, 3
    s_cbranch_scc1 L_ffrc
    ds_read_b64_tr_b16 v[4:5], v2 offset:15616
    ds_read_b64_tr_b16 v[6:7], v2 offset:15872
    ds_read_b64_tr_b16 v[8:9], v2 offset:17728
    ds_read_b64_tr_b16 v[10:11], v2 offset:17984
    ds_read_b64_tr_b16 v[12:13], v2 offset:19840
    ds_read_b64_tr_b16 v[14:15], v2 offset:20096
    ds_read_b64_tr_b16 v[16:17], v2 offset:21952
    ds_read_b64_tr_b16 v[18:19], v2 offset:22208
    ds_read_b64_tr_b16 v[20:21], v2 offset:24064
    ds_read_b64_tr_b16 v[22:23], v2 offset:24320
    ds_read_b64_tr_b16 v[24:25], v2 offset:26176
    ds_read_b64_tr_b16 v[26:27], v2 offset:26432
    ds_read_b64_tr_b16 v[28:29], v2 offset:28288
    ds_read_b64_tr_b16 v[30:31], v2 offset:28544
    ds_read_b64_tr_b16 v[32:33], v2 offset:30400
    ds_read_b64_tr_b16 v[34:35], v2 offset:30656
    ds_read_b64_tr_b16 v[36:37], v2 offset:32512
    ds_read_b64_tr_b16 v[38:39], v2 offset:32768
    ds_read_b64_tr_b16 v[40:41], v2 offset:34624
    ds_read_b64_tr_b16 v[42:43], v2 offset:34880
    ds_read_b64_tr_b16 v[44:45], v2 offset:36736
    ds_read_b64_tr_b16 v[46:47], v2 offset:36992
    ds_read_b64_tr_b16 v[48:49], v2 offset:38848
    ds_read_b64_tr_b16 v[50:51], v2 offset:39104
    ds_read_b64_tr_b16 v[52:53], v2 offset:40960
    ds_read_b64_tr_b16 v[54:55], v2 offset:41216
    ds_read_b64_tr_b16 v[56:57], v2 offset:43072
    ds_read_b64_tr_b16 v[58:59], v2 offset:43328
    ds_read_b64_tr_b16 v[60:61], v2 offset:45184
    ds_read_b64_tr_b16 v[62:63], v2 offset:45440
    ds_read_b64_tr_b16 v[64:65], v2 offset:47296
    ds_read_b64_tr_b16 v[66:67], v2 offset:47552
L_ffrc:
L_fx:
    s_barrier
    s_bitcmp1_b32 s42, 0
    s_cbranch_scc1 L_fm0
    global_load_dwordx4 v[84:87], v130, s[26:27] offset:-4096 sc1
L_fm0:
    s_bitcmp1_b32 s42, 1
    s_cbranch_scc1 L_fm1
    global_load_dwordx4 v[88:91], v130, s[26:27] offset:0 sc1
L_fm1:
    s_bitcmp1_b32 s42, 2
    s_cbranch_scc1 L_fm2
    global_load_dwordx4 v[92:95], v131, s[26:27] offset:-4096 sc1
L_fm2:
    s_bitcmp1_b32 s42, 3
    s_cbranch_scc1 L_fm3
    global_load_dwordx4 v[96:99], v131, s[26:27] offset:0 sc1
L_fm3:
    s_mov_b32 s39, 0
    ds_read_b32 v102, v100
    v_mov_b32 v104, 380
    v_mov_b32 v105, 1
    s_mov_b64 exec, 1
    ds_add_u32 v104, v105
    s_mov_b64 exec, -1
    s_waitcnt lgkmcnt(0)
    v_readfirstlane_b32 s40, v102
    s_mov_b32 s39, 0
    s_andn2_b32 s40, s40, s96
    s_cbranch_scc0 L_fnog
    s_mov_b32 s96, 1
    ds_read_b64_tr_b16 v[68:69], v3 offset:0
    ds_read_b64_tr_b16 v[70:71], v3 offset:4160
    ds_read_b64_tr_b16 v[72:73], v3 offset:8
    ds_read_b64_tr_b16 v[74:75], v3 offset:4168
    ds_read_b64_tr_b16 v[76:77], v3 offset:16
    ds_read_b64_tr_b16 v[78:79], v3 offset:4176
    ds_read_b64_tr_b16 v[80:81], v3 offset:24
    ds_read_b64_tr_b16 v[82:83], v3 offset:4184
    s_cmp_gt_u32 s31, 3
    s_cbranch_scc1 L_ffrb
    ds_read_b64_tr_b16 v[4:5], v2 offset:15616
    ds_read_b64_tr_b16 v[6:7], v2 offset:15872
    ds_read_b64_tr_b16 v[8:9], v2 offset:17728
    ds_read_b64_tr_b16 v[10:11], v2 offset:17984
    ds_read_b64_tr_b16 v[12:13], v2 offset:19840
    ds_read_b64_tr_b16 v[14:15], v2 offset:20096
    ds_read_b64_tr_b16 v[16:17], v2 offset:21952
    ds_read_b64_tr_b16 v[18:19], v2 offset:22208
    ds_read_b64_tr_b16 v[20:21], v2 offset:24064
    ds_read_b64_tr_b16 v[22:23], v2 offset:24320
    ds_read_b64_tr_b16 v[24:25], v2 offset:26176
    ds_read_b64_tr_b16 v[26:27], v2 offset:26432
    ds_read_b64_tr_b16 v[28:29], v2 offset:28288
    ds_read_b64_tr_b16 v[30:31], v2 offset:28544
    ds_read_b64_tr_b16 v[32:33], v2 offset:30400
    ds_read_b64_tr_b16 v[34:35], v2 offset:30656
    ds_read_b64_tr_b16 v[36:37], v2 offset:32512
    ds_read_b64_tr_b16 v[38:39], v2 offset:32768
    ds_read_b64_tr_b16 v[40:41], v2 offset:34624
    ds_read_b64_tr_b16 v[42:43], v2 offset:34880
    ds_read_b64_tr_b16 v[44:45], v2 offset:36736
    ds_read_b64_tr_b16 v[46:47], v2 offset:36992
    ds_read_b64_tr_b16 v[48:49], v2 offset:38848
    ds_read_b64_tr_b16 v[50:51], v2 offset:39104
    ds_read_b64_tr_b16 v[52:53], v2 offset:40960
    ds_read_b64_tr_b16 v[54:55], v2 offset:41216
    ds_read_b64_tr_b16 v[56:57], v2 offset:43072
    ds_read_b64_tr_b16 v[58:59], v2 offset:43328
    ds_read_b64_tr_b16 v[60:61], v2 offset:45184
    ds_read_b64_tr_b16 v[62:63], v2 offset:45440
    ds_read_b64_tr_b16 v[64:65], v2 offset:47296
    ds_read_b64_tr_b16 v[66:67], v2 offset:47552
L_ffrb:
L_fnog:
    s_branch L_poll26w
L_poll26:
    global_load_dwordx4 v[84:87], v130, s[26:27] offset:-4096 sc1
    global_load_dwordx4 v[88:91], v130, s[26:27] offset:0 sc1
    global_load_dwordx4 v[92:95], v131, s[26:27] offset:-4096 sc1
    global_load_dwordx4 v[96:99], v131, s[26:27] offset:0 sc1
    s_add_u32 s39, s39, 1
    s_cmp_gt_u32 s39, 524288
    s_cbranch_scc1 L_bail
L_poll26w:
    s_waitcnt vmcnt(0)
L_poll26c:
    v_perm_b32 v100, v85, v84, s36
    v_perm_b32 v101, v87, v86, s37
    v_perm_b32 v102, v89, v88, s36
    v_perm_b32 v103, v91, v90, s37
    v_perm_b32 v104, v93, v92, s36
    v_perm_b32 v105, v95, v94, s37
    v_perm_b32 v106, v97, v96, s36
    v_perm_b32 v107, v99, v98, s37
    v_bitop3_b32 v100, v100, v101, s32 bitop3:0x56
    v_bitop3_b32 v102, v102, v103, s32 bitop3:0x56
    v_bitop3_b32 v104, v104, v105, s32 bitop3:0x56
    v_bitop3_b32 v106, v106, v107, s32 bitop3:0x56
    v_or3_b32 v100, v100, v102, v104
    v_or_b32 v100, v100, v106
    v_cmp_ne_u32 vcc, 0, v100
    s_cbranch_vccnz L_poll26
    v_and_b32 v84, v128, v84
    v_and_b32 v85, v128, v85
    v_and_b32 v86, v128, v86
    v_and_b32 v87, v128, v87
    v_and_b32 v88, v128, v88
    v_and_b32 v89, v128, v89
    v_and_b32 v90, v128, v90
    v_and_b32 v91, v128, v91
    v_and_b32 v92, v128, v92
    v_and_b32 v93, v128, v93
    v_and_b32 v94, v128, v94
    v_and_b32 v95, v128, v95
    v_and_b32 v96, v128, v96
    v_and_b32 v97, v128, v97
    v_and_b32 v98, v128, v98
    v_and_b32 v99, v128, v99
    v_pk_add_f32 v[84:85], v[84:85], v[88:89]
    v_pk_add_f32 v[92:93], v[92:93], v[96:97]
    v_pk_add_f32 v[86:87], v[86:87], v[90:91]
    v_pk_add_f32 v[94:95], v[94:95], v[98:99]
    v_pk_add_f32 v[84:85], v[84:85], v[92:93]
    v_pk_add_f32 v[86:87], v[86:87], v[94:95]
    s_nop 1
    v_permlane16_swap_b32 v84, v86
    v_permlane16_swap_b32 v85, v87
    v_pk_add_f32 v[84:85], v[84:85], v[86:87]
    v_cvt_pk_bf16_f32 v84, 0, v84
    v_cvt_pk_bf16_f32 v85, 0, v85
    v_pk_add_f32 v[86:87], v[84:85], v[126:127]
    v_cvt_pk_bf16_f32 v84, 0, v86
    v_cvt_pk_bf16_f32 v85, 0, v87
    v_add_f32 v90, v84, v85
    v_mul_f32 v91, v84, v84
    v_fmac_f32 v91, v85, v85
    v_cvt_pk_bf16_f32 v88, v86, v87
    v_add_f32_dpp v90, v90, v90 row_ror:1 row_mask:0xf bank_mask:0xf
    v_add_f32_dpp v91, v91, v91 row_ror:1 row_mask:0xf bank_mask:0xf
    s_nop 0
    v_add_f32_dpp v90, v90, v90 row_ror:2 row_mask:0xf bank_mask:0xf
    v_add_f32_dpp v91, v91, v91 row_ror:2 row_mask:0xf bank_mask:0xf
    s_nop 0
    v_add_f32_dpp v90, v90, v90 row_ror:4 row_mask:0xf bank_mask:0xf
    v_add_f32_dpp v91, v91, v91 row_ror:4 row_mask:0xf bank_mask:0xf
    s_nop 0
    v_add_f32_dpp v90, v90, v90 row_ror:8 row_mask:0xf bank_mask:0xf
    v_add_f32_dpp v91, v91, v91 row_ror:8 row_mask:0xf bank_mask:0xf
    ds_write_b32 v136, v88 offset:13312
    v_add_f32_dpp v90, v90, v90 row_bcast:15 row_mask:0xa bank_mask:0xf
    v_add_f32_dpp v91, v91, v91 row_bcast:15 row_mask:0xa bank_mask:0xf
    s_mov_b32 exec_lo, 0x10000
    s_mov_b32 exec_hi, 0x10000
    ds_write_b64 v138, v[90:91] offset:10752
    s_mov_b64 exec, -1
    s_waitcnt lgkmcnt(0)
    s_barrier
    s_cmp_lt_u32 s31, 4
    s_cbranch_scc1 L_fgu
    s_lshl_b32 s40, s48, 3
    s_add_u32 s40, s40, s31
    s_cmp_lg_u32 s40, 7
    s_cbranch_scc1 L_fnb
    v_mov_b32 v4, 0
    v_mov_b32 v5, s32
    s_mov_b64 exec, 1
    global_store_dword v4, v5, s[26:27] sc1
    s_mov_b64 exec, -1
L_fnb:
    s_branch L_fact
L_fgu:
    s_cmp_lg_u32 s96, 0
    s_cbranch_scc1 L_fgu2
    ds_read_b64_tr_b16 v[4:5], v2 offset:15616
    ds_read_b64_tr_b16 v[6:7], v2 offset:15872
    ds_read_b64_tr_b16 v[8:9], v2 offset:17728
    ds_read_b64_tr_b16 v[10:11], v2 offset:17984
    ds_read_b64_tr_b16 v[12:13], v2 offset:19840
    ds_read_b64_tr_b16 v[14:15], v2 offset:20096
    ds_read_b64_tr_b16 v[16:17], v2 offset:21952
    ds_read_b64_tr_b16 v[18:19], v2 offset:22208
    ds_read_b64_tr_b16 v[20:21], v2 offset:24064
    ds_read_b64_tr_b16 v[22:23], v2 offset:24320
    ds_read_b64_tr_b16 v[24:25], v2 offset:26176
    ds_read_b64_tr_b16 v[26:27], v2 offset:26432
    ds_read_b64_tr_b16 v[28:29], v2 offset:28288
    ds_read_b64_tr_b16 v[30:31], v2 offset:28544
    ds_read_b64_tr_b16 v[32:33], v2 offset:30400
    ds_read_b64_tr_b16 v[34:35], v2 offset:30656
    ds_read_b64_tr_b16 v[36:37], v2 offset:32512
    ds_read_b64_tr_b16 v[38:39], v2 offset:32768
    ds_read_b64_tr_b16 v[40:41], v2 offset:34624
    ds_read_b64_tr_b16 v[42:43], v2 offset:34880
    ds_read_b64_tr_b16 v[44:45], v2 offset:36736
    ds_read_b64_tr_b16 v[46:47], v2 offset:36992
    ds_read_b64_tr_b16 v[48:49], v2 offset:38848
    ds_read_b64_tr_b16 v[50:51], v2 offset:39104
    ds_read_b64_tr_b16 v[52:53], v2 offset:40960
    ds_read_b64_tr_b16 v[54:55], v2 offset:41216
    ds_read_b64_tr_b16 v[56:57], v2 offset:43072
    ds_read_b64_tr_b16 v[58:59], v2 offset:43328
    ds_read_b64_tr_b16 v[60:61], v2 offset:45184
    ds_read_b64_tr_b16 v[62:63], v2 offset:45440
    ds_read_b64_tr_b16 v[64:65], v2 offset:47296
    ds_read_b64_tr_b16 v[66:67], v2 offset:47552
    s_waitcnt lgkmcnt(0)
L_fgu2:
    ds_read_b128 v[84:87], v139 offset:0
    ds_read_b128 v[88:91], v139 offset:64
    ds_read_b128 v[92:95], v139 offset:128
    ds_read_b128 v[96:99], v139 offset:192
    ds_read_b128 v[148:151], v137 offset:10752
    ds_read_b128 v[152:155], v137 offset:10768
    ds_read_b128 v[156:159], v137 offset:10784
    ds_read_b128 v[124:127], v137 offset:10800
    ds_read_b128 v[100:103], v139 offset:256
    ds_read_b128 v[104:107], v139 offset:320
    ds_read_b128 v[108:111], v139 offset:384
    ds_read_b128 v[112:115], v139 offset:448
    s_waitcnt lgkmcnt(11)
    v_mfma_f32_16x16x32_bf16 v[116:119], v[84:87], v[4:7], 0
    ds_read_b128 v[84:87], v139 offset:512
    s_waitcnt lgkmcnt(11)
    v_mfma_f32_16x16x32_bf16 v[116:119], v[88:91], v[8:11], v[116:119]
    ds_read_b128 v[88:91], v139 offset:576
    s_waitcnt lgkmcnt(11)
    v_mfma_f32_16x16x32_bf16 v[116:119], v[92:95], v[12:15], v[116:119]
    ds_read_b128 v[92:95], v139 offset:640
    s_waitcnt lgkmcnt(11)
    v_mfma_f32_16x16x32_bf16 v[116:119], v[96:99], v[16:19], v[116:119]
    ds_read_b128 v[96:99], v139 offset:704
    s_waitcnt lgkmcnt(7)
    v_mfma_f32_16x16x32_bf16 v[116:119], v[100:103], v[20:23], v[116:119]
    ds_read_b128 v[100:103], v139 offset:768
    v_pk_add_f32 v[148:149], v[148:149], v[150:151]
    v_pk_add_f32 v[152:153], v[152:153], v[154:155]
    s_waitcnt lgkmcnt(7)
    v_mfma_f32_16x16x32_bf16 v[116:119], v[104:107], v[24:27], v[116:119]
    ds_read_b128 v[104:107], v139 offset:832
    v_pk_add_f32 v[156:157], v[156:157], v[158:159]
    v_pk_add_f32 v[124:125], v[124:125], v[126:127]
    s_waitcnt lgkmcnt(7)
    v_mfma_f32_16x16x32_bf16 v[116:119], v[108:111], v[28:31], v[116:119]
    ds_read_b128 v[108:111], v139 offset:896
    v_pk_add_f32 v[148:149], v[148:149], v[152:153]
    v_pk_add_f32 v[156:157], v[156:157], v[124:125]
    s_waitcnt lgkmcnt(7)
    v_mfma_f32_16x16x32_bf16 v[116:119], v[112:115], v[32:35], v[116:119]
    ds_read_b128 v[112:115], v139 offset:960
    v_pk_add_f32 v[148:149], v[148:149], v[156:157]
    v_mul_f32 v148, 0x3b000000, v148
    s_waitcnt lgkmcnt(7)
    v_mfma_f32_16x16x32_bf16 v[116:119], v[84:87], v[36:39], v[116:119]
    v_mul_f32 v149, 0x3b000000, v149
    v_fma_f32 v149, -v148, v148, v149
    s_waitcnt lgkmcnt(6)
    v_mfma_f32_16x16x32_bf16 v[116:119], v[88:91], v[40:43], v[116:119]
    v_max_f32 v149, 0, v149
    v_cvt_pk_bf16_f32 v149, 0, v149
    s_waitcnt lgkmcnt(5)
    v_mfma_f32_16x16x32_bf16 v[116:119], v[92:95], v[44:47], v[116:119]
    v_cvt_pk_bf16_f32 v120, 0, v148
    v_add_f32 v149, 0x3727c5ac, v149
    s_waitcnt lgkmcnt(4)
    v_mfma_f32_16x16x32_bf16 v[116:119], v[96:99], v[48:51], v[116:119]
    v_cvt_pk_bf16_f32 v149, 0, v149
    v_sqrt_f32 v149, v149
    s_waitcnt lgkmcnt(3)
    v_mfma_f32_16x16x32_bf16 v[116:119], v[100:103], v[52:55], v[116:119]
    v_cvt_pk_bf16_f32 v122, 0, v149
    v_rcp_f32 v124, v122
    s_waitcnt lgkmcnt(2)
    v_mfma_f32_16x16x32_bf16 v[116:119], v[104:107], v[56:59], v[116:119]
    s_waitcnt lgkmcnt(1)
    v_mfma_f32_16x16x32_bf16 v[116:119], v[108:111], v[60:63], v[116:119]
    s_waitcnt lgkmcnt(0)
    v_mfma_f32_16x16x32_bf16 v[116:119], v[112:115], v[64:67], v[116:119]
    s_nop 7
    v_cndmask_b32 v4, v116, v117, s[46:47]
    v_fma_f32 v4, -v120, v118, v4
    v_mul_f32 v4, v4, v124
    v_cvt_pk_bf16_f32 v4, 0, v4
    v_mul_f32 v6, v4, v4
    v_mul_f32 v7, s51, v4
    v_mov_b32_dpp v5, v4 row_ror:8 row_mask:0xf bank_mask:0xf
    v_fma_f32 v6, v6, s49, 1.0
    v_mul_f32 v6, v6, v7
    v_exp_f32 v6, v6
    s_nop 0
    v_add_f32 v6, 1.0, v6
    v_rcp_f32 v6, v6
    s_nop 0
    v_mul_f32 v4, v4, v6
    v_cvt_pk_bf16_f32 v4, 0, v4
    v_mul_f32 v4, v4, v5
    v_cvt_pk_bf16_f32 v4, v4, v4
    s_mov_b64 exec, 0x00ff00ff
    ds_write_b16 v140, v4 offset:11008
    s_mov_b64 exec, -1
L_fact:
    ds_read_u16 v146, v135 offset:13312
    v_mov_b32 v84, 0
    v_mov_b32 v85, 0
    v_mov_b32 v86, 0
    v_mov_b32 v87, 0
    v_mov_b32 v88, 0
    v_mov_b32 v89, 0
    v_mov_b32 v90, 0
    v_mov_b32 v91, 0
    v_mov_b32 v92, 0
    v_mov_b32 v93, 0
    v_mov_b32 v94, 0
    v_mov_b32 v95, 0
    v_mov_b32 v96, 0
    v_mov_b32 v97, 0
    v_mov_b32 v98, 0
    v_mov_b32 v99, 0
    s_waitcnt lgkmcnt(0)
    s_barrier
    s_cmp_lg_u32 s96, 0
    s_cbranch_scc1 L_fdn
    ds_read_b64_tr_b16 v[68:69], v3 offset:0
    ds_read_b64_tr_b16 v[70:71], v3 offset:4160
    ds_read_b64_tr_b16 v[72:73], v3 offset:8
    ds_read_b64_tr_b16 v[74:75], v3 offset:4168
    ds_read_b64_tr_b16 v[76:77], v3 offset:16
    ds_read_b64_tr_b16 v[78:79], v3 offset:4176
    ds_read_b64_tr_b16 v[80:81], v3 offset:24
    ds_read_b64_tr_b16 v[82:83], v3 offset:4184
L_fdn:
    s_mov_b32 exec_lo, 0x11111111
    s_mov_b32 exec_hi, 0x11111111
    ds_read_b128 v[84:87], v141 offset:11008
    s_mov_b32 exec_lo, 0x22222222
    s_mov_b32 exec_hi, 0x22222222
    ds_read_b128 v[88:91], v141 offset:11008
    s_mov_b32 exec_lo, 0x44444444
    s_mov_b32 exec_hi, 0x44444444
    ds_read_b128 v[92:95], v141 offset:11008
    s_mov_b32 exec_lo, 0x88888888
    s_mov_b32 exec_hi, 0x88888888
    ds_read_b128 v[96:99], v141 offset:11008
    s_mov_b64 exec, -1
    v_lshlrev_b32 v146, 16, v146
    s_waitcnt lgkmcnt(0)
    v_mfma_f32_16x16x32_bf16 v[116:119], v[68:71], v[84:87], 0
    v_mfma_f32_16x16x32_bf16 v[116:119], v[72:75], v[88:91], v[116:119]
    v_mfma_f32_16x16x32_bf16 v[116:119], v[76:79], v[92:95], v[116:119]
    v_mfma_f32_16x16x32_bf16 v[116:119], v[80:83], v[96:99], v[116:119]
    s_mov_b32 exec_lo, 0x00ff00ff
    s_mov_b32 exec_hi, 0x00ff00ff
    s_nop 5
    v_bfi_b32 v116, v128, v116, s32
    v_bfi_b32 v117, v128, v117, s33
    v_bfi_b32 v118, v128, v118, s34
    v_bfi_b32 v119, v128, v119, s35
    global_store_dwordx4 v134, v[116:119], s[26:27] sc1
    s_mov_b64 exec, -1
    s_cmp_ge_u32 s48, 32
    s_cbranch_scc1 L_none
    s_cmp_ge_u32 s31, 2
    s_cbranch_scc1 L_none
    s_waitcnt vmcnt(0)
    s_mov_b32 s39, 0
L_poll27:
    global_load_dwordx4 v[84:87], v142, s[26:27] sc1
    global_load_dwordx4 v[88:91], v142, s[26:27] offset:2048 sc1
    global_load_dwordx4 v[92:95], v143, s[26:27] sc1
    s_add_u32 s39, s39, 1
    s_cmp_gt_u32 s39, 524288
    s_cbranch_scc1 L_bail
L_poll27w:
    s_waitcnt vmcnt(0)
L_poll27c:
    v_perm_b32 v96, v85, v84, s36
    v_perm_b32 v97, v87, v86, s37
    v_perm_b32 v98, v89, v88, s36
    v_perm_b32 v99, v91, v90, s37
    v_perm_b32 v100, v93, v92, s36
    v_perm_b32 v101, v95, v94, s37
    v_bitop3_b32 v96, v96, v97, s32 bitop3:0x56
    v_bitop3_b32 v98, v98, v99, s32 bitop3:0x56
    v_bitop3_b32 v100, v100, v101, s32 bitop3:0x56
    v_or3_b32 v96, v96, v98, v100
    v_cmp_ne_u32 vcc, 0, v96
    s_cbranch_vccnz L_poll27
    v_and_b32 v84, v128, v84
    v_and_b32 v85, v128, v85
    v_and_b32 v86, v128, v86
    v_and_b32 v87, v128, v87
    v_and_b32 v88, v128, v88
    v_and_b32 v89, v128, v89
    v_and_b32 v90, v128, v90
    v_and_b32 v91, v128, v91
    v_and_b32 v92, v144, v92
    v_and_b32 v93, v144, v93
    v_and_b32 v94, v144, v94
    v_and_b32 v95, v144, v95
    v_pk_add_f32 v[84:85], v[84:85], v[88:89]
    v_pk_add_f32 v[86:87], v[86:87], v[90:91]
    v_pk_add_f32 v[84:85], v[84:85], v[92:93]
    v_pk_add_f32 v[86:87], v[86:87], v[94:95]
    s_nop 0
    v_permlane32_swap_b32 v84, v85
    v_permlane32_swap_b32 v86, v87
    v_add_f32 v84, v84, v85
    v_add_f32 v86, v86, v87
    s_nop 1
    v_permlane16_swap_b32 v84, v86
    v_add_f32 v84, v84, v86
    s_nop 1
    v_add_f32_dpp v84, v84, v84 row_ror:4 row_mask:0xf bank_mask:0xf
    s_nop 1
    v_add_f32_dpp v84, v84, v84 row_ror:8 row_mask:0xf bank_mask:0xf
    v_cvt_pk_bf16_f32 v84, 0, v84
    s_mov_b32 exec_lo, 0x000f000f
    s_mov_b32 exec_hi, 0x000f000f
    v_add_f32 v84, v84, v146
    v_cvt_pk_bf16_f32 v84, v84, v84
    global_store_short v145, v84, s[22:23] nt
    s_endpgm
L_none:
    s_endpgm
L_bail:
    s_endpgm
L_codeend:
.fill 256, 4, 0xbf810000
.section .rodata,"a"
.p2align 6
.amdhsa_kernel sequential_preLN__sliding_block_cached__geglu_ffn__decode_kernel
  .amdhsa_next_free_vgpr 160
  .amdhsa_next_free_sgpr 102
  .amdhsa_accum_offset 160
  .amdhsa_group_segment_fixed_size 0
  .amdhsa_kernarg_size 96
  .amdhsa_user_sgpr_count 2
  .amdhsa_user_sgpr_kernarg_segment_ptr 1
  .amdhsa_system_sgpr_workgroup_id_x 1
.end_amdhsa_kernel
```
